```python
import torch

def _softmax(x, axis=-1):
    return torch.softmax(x, dim=axis)
def _gelu(x):
    return torch.nn.functional.gelu(x, approximate="tanh")
def _silu(x):
    return torch.nn.functional.silu(x)
def _sigmoid(x):
    return torch.sigmoid(x)
def _layernorm(x, axis=-1, eps=1e-5):
    m = x.mean(dim=axis, keepdim=True)
    v = x.var(dim=axis, keepdim=True, unbiased=False)
    return (x - m) / torch.sqrt(v + eps)
def _scatter_add(tgt, idx, src, axis=0):
    return tgt.clone().index_add_(axis, idx, src)
def _segment_sum(src, seg, n):
    out = torch.zeros((n,) + src.shape[1:], dtype=src.dtype)
    return out.index_add_(0, seg, src)
def _pad(x, pw):
    flat = tuple(v for pair in reversed(pw) for v in pair)
    return torch.nn.functional.pad(x, flat)

kernel_name = 'standalone__gqa_block_cached__sampling'

def setup_inputs():

    _w = (lambda a: (lambda t: t.to(torch.bfloat16) if t.is_floating_point() else t)(torch.as_tensor(a)))
    B, Sq, D = 16, 32, 512
    Hq, Hkv, Sk, Dh = 32, 8, 4096, 128
    assert Hq % Hkv == 0, (Hq, Hkv)
    return {
        "x": _w((lambda *s: torch.randn(*s, dtype=torch.bfloat16) * 0.8)(B, Sq, D)),
        "k_cache": _w((lambda *s: torch.randn(*s, dtype=torch.bfloat16) * 0.8)(B, Hkv, Sk, Dh)),
        "v_cache": _w((lambda *s: torch.randn(*s, dtype=torch.bfloat16) * 0.05)(B, Hkv, Sk, Dh)),
        "wq": _w((lambda *s: torch.randn(*s, dtype=torch.bfloat16) * 0.8)(D, Hq * Dh) * (D ** -0.5)),
        "wo": _w((lambda *s: torch.randn(*s, dtype=torch.bfloat16) * 0.05)(Hq * Dh, D) * ((Hq * Dh) ** -0.5)),
    }

def reference(x, k_cache, v_cache, wq, wo):
    B, Sq, D = x.shape
    Hq, Dh = 32, 128
    Hkv = k_cache.shape[1]
    rep = Hq // Hkv
    q = (lambda x, *d: x.permute(*d))((x @ wq).reshape(B, Sq, Hq, Dh), 0, 2, 1, 3)
    k = (lambda x, n, axis: torch.repeat_interleave(x, n, dim=axis))(k_cache, rep, axis=1)
    v = (lambda x, n, axis: torch.repeat_interleave(x, n, dim=axis))(v_cache, rep, axis=1)
    scores = torch.einsum("bhqd,bhkd->bhqk", q, k) * (Dh ** -0.5)
    p = _softmax(scores, axis=-1)
    o = torch.einsum("bhqk,bhkd->bhqd", p, v)
    return (lambda x, *d: x.permute(*d))(o, 0, 2, 1, 3).reshape(B, Sq, Hq * Dh) @ wo
```

```asm
; @launch grid=(256,1,1) block=(256,1,1) lds=163840
.amdgcn_target "amdgcn-amd-amdhsa--gfx950"
.text
.globl standalone__gqa_block_cached__sampling_kernel
.p2align 8
.type standalone__gqa_block_cached__sampling_kernel,@function
standalone__gqa_block_cached__sampling_kernel:
s_cmp_ge_u32 s2, 256
s_cbranch_scc1 L_end
s_load_dwordx16 s[64:79], s[0:1], 0
s_getpc_b64 s[4:5]
L_pc:
v_lshlrev_b32_e64 v1, 7, v0
s_mov_b32 s6, L_codeend-L_pc
s_cmp_ge_u32 s2, 8
s_cbranch_scc1 L_nopf
v_cmp_gt_u32_e64 vcc, s6, v1
s_and_saveexec_b64 s[6:7], vcc
s_cbranch_execz L_nopf
global_load_dword v255, v1, s[4:5]
L_nopf:
s_mov_b64 exec, -1
v_lshrrev_b32 v4, 6, v0
v_and_b32 v3, 63, v0
v_readfirstlane_b32 s40, v4
s_and_b32 s41, s2, 1
s_lshr_b32 s42, s2, 4
s_bfe_u32 s3, s2, 0x10003
s_mov_b32 s4, 1
s_lshl_b32 s5, s4, 1
s_and_b32 s4, s5, 2
s_and_b32 s5, s5, 4
s_cmp_eq_u32 s41, 0
s_cselect_b32 s4, s5, s4
s_and_b32 s5, s2, 6
s_xor_b32 s5, s5, s4
s_add_u32 s43, s5, s3
s_mul_i32 s47, s40, 4224
s_mov_b32 s55, 4294832128
s_mov_b32 s54, 0
s_mov_b32 s44, 0
s_mov_b32 s50, 8192
v_lshlrev_b32 v238, 4, v3
v_add_u32 v236, 96, v238
v_add_u32 v237, 64, v238
v_add_u32 v241, 32, v238
v_add_u32_e64 v252, 0, v238
s_cmp_eq_u32 s41, s3
s_cselect_b32 s52, 0, 4
s_mul_i32 s4, s41, 2
s_sub_u32 s4, 63, s4
s_add_u32 s52, s52, s4
s_lshr_b32 s46, s40, 1
s_mul_i32 s48, s46, -8192
s_lshl_b32 s5, s42, 3
s_add_u32 s5, s5, s43
s_lshl_b32 s5, s5, 7
s_sub_u32 s4, 128, s52
s_mul_i32 s4, s4, s41
s_add_u32 s5, s5, s4
s_lshl_b32 s5, s5, 13
s_and_b32 s4, s40, 1
s_lshl_b32 s4, s4, 12
s_add_u32 s5, s5, s4
s_lshl_b32 s6, s52, 13
s_sub_u32 s6, s6, s4
s_add_u32 s10, s6, 96
s_sub_u32 s6, s5, 96
s_subb_u32 s7, 0, 0
s_cmp_eq_u32 s41, s3
s_cbranch_scc1 L_roleA
s_lshl_b32 s4, s42, 15
v_add_u32 v1, s4, v1
v_lshrrev_b32 v8, 10, v1
v_lshlrev_b32 v8, 13, v8
v_and_b32 v5, 0x380, v1
s_and_b32 s4, s2, 7
s_lshl_b32 s4, s4, 10
v_add3_u32 v8, v8, v5, s4
s_waitcnt lgkmcnt(0)
s_mov_b32 s0, 135168
s_cmp_lg_u32 s42, 1
s_cbranch_scc1 L_noinit
s_mov_b32 s32, s76
s_and_b32 s33, s77, 0xffff
s_mov_b32 s34, 256
s_mov_b32 s35, 0x20000
s_mov_b32 s36, s78
s_and_b32 s37, s79, 0xffff
s_mov_b32 s38, 536870912
s_mov_b32 s39, 0x20000
v_lshlrev_b32 v246, 4, v0
v_mov_b32 v12, 0
v_mov_b32 v13, 0
v_mov_b32 v14, 0
v_mov_b32 v15, 0
s_and_b32 s4, s2, 7
s_lshl_b32 s4, s4, 13
s_add_u32 s4, s4, 33554432
s_add_u32 s5, s4, 4096
buffer_store_dwordx4 v[12:15], v246, s[36:39], s4 offen sc1
buffer_store_dwordx4 v[12:15], v246, s[36:39], s5 offen sc1
s_waitcnt vmcnt(0)
s_barrier
s_cmp_lg_u32 s40, 0
s_cbranch_scc1 L_noinit
v_mov_b32 v246, 1
s_mov_b64 exec, 1
buffer_atomic_add v246, v12, s[32:35], 0 offen sc1
s_mov_b64 exec, -1
L_noinit:
s_mov_b32 s20, s70
s_and_b32 s21, s71, 0xffff
s_mov_b32 s22, 4194304
s_mov_b32 s23, 0x20000
s_mov_b32 s16, s64
s_nop 0
s_and_b32 s17, s65, 0xffff
s_mov_b32 s18, 524288
s_mov_b32 s19, 0x20000
buffer_load_dword v255, v8, s[20:23], 0 offen
buffer_load_dword v255, v1, s[16:19], 0 offen
s_cmp_eq_u32 s46, 0
s_cselect_b32 s8, s66, s68
s_cselect_b32 s9, s67, s69
s_add_u32 s8, s8, s6
s_addc_u32 s9, s9, s7
s_and_b32 s9, s9, 0xffff
s_mov_b32 s11, 0x20000
s_mov_b32 s32, s76
s_and_b32 s33, s77, 0xffff
s_mov_b32 s34, 256
s_mov_b32 s35, 0x20000
s_mov_b32 s36, s78
s_nop 0
s_and_b32 s37, s79, 0xffff
s_mov_b32 s38, 536870912
s_mov_b32 s39, 0x20000
s_sub_u32 s24, s72, 96
s_subb_u32 s25, s73, 0
s_and_b32 s25, s25, 0xffff
s_mov_b32 s26, 4194400
s_mov_b32 s27, 0x20000
s_mov_b32 s28, s74
s_and_b32 s29, s75, 0xffff
s_mov_b32 s30, 524288
s_mov_b32 s31, 0x20000
v_bfe_u32 v4, v3, 2, 1
v_and_b32_e64 v5, 3, v3
v_lshl_add_u32 v4, v4, 2, v5
v_mul_u32_u24 v4, 1056, v4
v_bfe_u32 v6, v3, 3, 1
v_lshl_add_u32 v4, v6, 8, v4
v_and_b32 v6, 48, v3
v_add_u32 v239, v4, v6
v_bfe_u32 v4, v3, 2, 3
v_mul_u32_u24 v4, 1056, v4
v_lshrrev_b32_e64 v6, 5, v3
v_lshl_add_u32 v7, v6, 8, v4
v_lshl_add_u32 v240, v5, 3, v7
v_add_u32 v240, 8448, v240
v_lshrrev_b32_e64 v4, 2, v3
v_mul_u32_u24 v4, 1056, v4
v_lshl_add_u32 v4, v5, 4, v4
s_lshl_b32 s4, s40, 8
v_add_u32 v4, s4, v4
v_add_u32 v254, 84480, v4
v_cmp_eq_u32_e64 vcc, 0, v5
v_mov_b32 v4, 0x3f803f80
s_nop 0
v_cndmask_b32 v232, 0, v4, vcc
v_cndmask_b32 v233, 0, v4, vcc
v_cndmask_b32 v234, 0, v4, vcc
v_cndmask_b32 v235, 0, v4, vcc
s_lshr_b32 s4, s2, 3
s_mul_i32 s5, s4, 3641
s_lshr_b32 s5, s5, 16
s_mul_i32 s5, s5, 18
s_sub_u32 s4, s4, s5
s_add_u32 s53, s4, 1
s_cmp_gt_u32 s53, 9
s_cselect_b32 s4, 18, 9
s_sub_u32 s4, s4, s53
s_mul_i32 s44, s4, 16896
s_mov_b32 s54, s44
v_add_u32 v239, s44, v239
v_add_u32 v240, s44, v240
s_mul_i32 s4, s41, 2
s_sub_u32 s1, 63, s4
s_mov_b32 s58, 0x24b2c991
s_mov_b32 s59, 0x49
s_lshl_b64 s[58:59], s[58:59], s53
s_min_u32 s1, s1, 63
s_bitset1_b64 s[58:59], s1
s_mov_b32 s56, 0x208101
s_mov_b32 s57, 0x0
s_lshl_b64 s[56:57], s[56:57], s53
s_mov_b32 s96, 0
v_mov_b32 v0, 0
v_mov_b32 v1, 0
v_mov_b32 v2, 0
v_mov_b32 v3, 0
v_mov_b32 v4, 0
v_mov_b32 v5, 0
v_mov_b32 v6, 0
v_mov_b32 v7, 0
v_mov_b32 v8, 0
v_mov_b32 v9, 0
v_mov_b32 v10, 0
v_mov_b32 v11, 0
v_mov_b32 v12, 0
v_mov_b32 v13, 0
v_mov_b32 v14, 0
v_mov_b32 v15, 0
v_mov_b32 v16, 0
v_mov_b32 v17, 0
v_mov_b32 v18, 0
v_mov_b32 v19, 0
v_mov_b32 v20, 0
v_mov_b32 v21, 0
v_mov_b32 v22, 0
v_mov_b32 v23, 0
v_mov_b32 v24, 0
v_mov_b32 v25, 0
v_mov_b32 v26, 0
v_mov_b32 v27, 0
v_mov_b32 v28, 0
v_mov_b32 v29, 0
v_mov_b32 v30, 0
v_mov_b32 v31, 0
v_mov_b32 v32, 0
v_mov_b32 v33, 0
v_mov_b32 v34, 0
v_mov_b32 v35, 0
v_mov_b32 v36, 0
v_mov_b32 v37, 0
v_mov_b32 v38, 0
v_mov_b32 v39, 0
v_mov_b32 v40, 0
v_mov_b32 v41, 0
v_mov_b32 v42, 0
v_mov_b32 v43, 0
v_mov_b32 v44, 0
v_mov_b32 v45, 0
v_mov_b32 v46, 0
v_mov_b32 v47, 0
v_mov_b32 v48, 0
v_mov_b32 v49, 0
v_mov_b32 v50, 0
v_mov_b32 v51, 0
v_mov_b32 v52, 0
v_mov_b32 v53, 0
v_mov_b32 v54, 0
v_mov_b32 v55, 0
v_mov_b32 v56, 0
v_mov_b32 v57, 0
v_mov_b32 v58, 0
v_mov_b32 v59, 0
v_mov_b32 v60, 0
v_mov_b32 v61, 0
v_mov_b32 v62, 0
v_mov_b32 v63, 0
v_mov_b32 v176, 0
v_mov_b32 v177, 0
v_mov_b32 v178, 0
v_mov_b32 v179, 0
v_mov_b32 v180, 0
v_mov_b32 v181, 0
v_mov_b32 v182, 0
v_mov_b32 v183, 0
v_mov_b32 v184, 0
v_mov_b32 v185, 0
v_mov_b32 v186, 0
v_mov_b32 v187, 0
v_mov_b32 v188, 0
v_mov_b32 v189, 0
v_mov_b32 v190, 0
v_mov_b32 v191, 0
v_mov_b32 v192, 0
v_mov_b32 v193, 0
v_mov_b32 v194, 0
v_mov_b32 v195, 0
v_mov_b32 v196, 0
v_mov_b32 v197, 0
v_mov_b32 v198, 0
v_mov_b32 v199, 0
v_mov_b32 v200, 0
v_mov_b32 v201, 0
v_mov_b32 v202, 0
v_mov_b32 v203, 0
v_mov_b32 v204, 0
v_mov_b32 v205, 0
v_mov_b32 v206, 0
v_mov_b32 v207, 0
v_mov_b32 v136, 0
v_mov_b32 v137, 0
v_mov_b32 v138, 0
v_mov_b32 v139, 0
v_mov_b32 v140, 0
v_mov_b32 v141, 0
v_mov_b32 v142, 0
v_mov_b32 v143, 0
v_mov_b32 v216, 0
v_mov_b32 v217, 0
v_mov_b32 v218, 0
v_mov_b32 v219, 0
v_mov_b32 v220, 0
v_mov_b32 v221, 0
v_mov_b32 v222, 0
v_mov_b32_e64 v223, 0
s_mov_b32 s3, 0
L_fillB:
s_add_u32 m0, s54, s47
s_cmp_eq_u32 s54, s0
s_cselect_b32 s45, s55, 16896
s_add_u32 s54, s54, s45
s_nop 0
buffer_load_dwordx4 v236, s[8:11], s48 offen offset:0 nt lds
buffer_load_dwordx4 v237, s[8:11], s48 offen offset:1056 nt lds
buffer_load_dwordx4 v241, s[8:11], s48 offen offset:2112 nt lds
buffer_load_dwordx4 v252, s[8:11], s48 offen offset:3168 nt lds
s_add_u32 s48, s48, s50
s_add_u32 s3, s3, 1
s_cmp_lt_u32 s3, 9
s_cbranch_scc1 L_fillB
s_cmp_lg_u32 s40, 0
s_cbranch_scc1 L_join
v_mov_b32_e64 v246, 0
s_mov_b32 s3, 0x40000
L_spinIB:
buffer_load_dword v247, v246, s[32:35], 0 offen sc1
s_sub_u32 s3, s3, 1
s_cbranch_scc1 L_spinIB_x
s_waitcnt vmcnt(0)
v_readfirstlane_b32 s4, v247
s_cmp_lt_u32 s4, 8
s_cbranch_scc1 L_spinIB
L_spinIB_x:
s_branch L_join
L_roleA:
s_and_b32 s60, s42, 3
s_lshr_b32 s4, s42, 2
s_and_b32 s5, s2, 7
s_lshl_b32 s61, s5, 2
s_add_u32 s61, s61, s4
s_add_u32 s4, s4, s60
s_and_b32 s4, s4, 3
s_lshl_b32 s62, s4, 8
s_lshl_b32 s63, s4, 20
s_lshl_b32 s56, s60, 17
s_lshl_b32 s4, s40, 15
s_add_u32 s56, s56, s4
s_lshl_b32 s57, s61, 8
s_lshr_b32 s4, s40, 1
s_lshl_b32 s4, s4, 18
s_add_u32 s57, s57, s4
s_and_b32 s4, s40, 1
s_lshl_b32 s4, s4, 16
s_add_u32 s57, s57, s4
s_lshl_b32 s97, s40, 12
v_lshrrev_b32 v4, 4, v3
v_and_b32 v5, 7, v3
v_xor_b32 v5, v4, v5
v_lshrrev_b32 v6, 3, v3
v_lshlrev_b32 v6, 10, v6
v_lshl_add_u32 v208, v5, 4, v6
v_xor_b32_e64 v5, 64, v208
v_add_u32 v209, 7168, v5
v_add_u32 v210, 14336, v208
v_add_u32 v211, 21504, v5
v_and_b32 v5, 1, v4
v_lshlrev_b32 v5, 17, v5
v_lshrrev_b32_e64 v6, 1, v4
v_lshl_add_u32 v5, v6, 15, v5
v_and_b32_e64 v6, 15, v3
v_lshl_add_u32 v212, v6, 4, v5
v_add_u32 v213, 7136, v212
v_add_u32 v214, 14272, v212
v_add_u32 v215, 21408, v212
s_waitcnt lgkmcnt(0)
s_mov_b32 s0, 135168
s_mov_b32 s16, s64
s_and_b32 s17, s65, 0xffff
s_mov_b32 s18, 524288
s_mov_b32 s19, 0x20000
s_mov_b32 s20, s70
s_and_b32 s21, s71, 0xffff
s_mov_b32 s22, 4194304
s_mov_b32 s23, 0x20000
s_add_u32 m0, s97, 0
s_add_u32 s96, s56, s62
s_nop 0
buffer_load_dwordx4 v208, s[16:19], s96 offen offset:0  lds
buffer_load_dwordx4 v209, s[16:19], s96 offen offset:1024  lds
buffer_load_dwordx4 v210, s[16:19], s96 offen offset:2048  lds
buffer_load_dwordx4 v211, s[16:19], s96 offen offset:3072  lds
s_add_u32 s62, s62, 128
s_and_b32 s62, s62, 1023
s_add_u32 m0, s47, 16896
s_add_u32 s96, s57, s63
s_nop 0
buffer_load_dwordx4 v212, s[20:23], s96 offen offset:0  lds
buffer_load_dwordx4 v213, s[20:23], s96 offen offset:1056  lds
buffer_load_dwordx4 v214, s[20:23], s96 offen offset:2112  lds
buffer_load_dwordx4 v215, s[20:23], s96 offen offset:3168  lds
s_add_u32 s63, s63, 524288
s_and_b32 s63, s63, 4194303
s_add_u32 m0, s97, 33792
s_add_u32 s96, s56, s62
s_nop 0
buffer_load_dwordx4 v208, s[16:19], s96 offen offset:0  lds
buffer_load_dwordx4 v209, s[16:19], s96 offen offset:1024  lds
buffer_load_dwordx4 v210, s[16:19], s96 offen offset:2048  lds
buffer_load_dwordx4 v211, s[16:19], s96 offen offset:3072  lds
s_add_u32 s62, s62, 128
s_and_b32 s62, s62, 1023
s_add_u32 m0, s47, 50688
s_add_u32 s96, s57, s63
s_nop 0
buffer_load_dwordx4 v212, s[20:23], s96 offen offset:0  lds
buffer_load_dwordx4 v213, s[20:23], s96 offen offset:1056  lds
buffer_load_dwordx4 v214, s[20:23], s96 offen offset:2112  lds
buffer_load_dwordx4 v215, s[20:23], s96 offen offset:3168  lds
s_add_u32 s63, s63, 524288
s_and_b32 s63, s63, 4194303
s_cmp_eq_u32 s46, 0
s_cselect_b32 s8, s66, s68
s_cselect_b32 s9, s67, s69
s_add_u32 s8, s8, s6
s_addc_u32 s9, s9, s7
s_and_b32 s9, s9, 0xffff
s_mov_b32 s11, 0x20000
s_mov_b32 s32, s76
s_and_b32 s33, s77, 0xffff
s_mov_b32 s34, 256
s_mov_b32 s35, 0x20000
s_mov_b32 s36, s78
s_nop 0
s_and_b32 s37, s79, 0xffff
s_mov_b32 s38, 536870912
s_mov_b32 s39, 0x20000
s_sub_u32 s24, s72, 96
s_subb_u32 s25, s73, 0
s_and_b32 s25, s25, 0xffff
s_mov_b32 s26, 4194400
s_mov_b32 s27, 0x20000
s_mov_b32 s28, s74
s_and_b32 s29, s75, 0xffff
s_mov_b32 s30, 524288
s_mov_b32 s31, 0x20000
v_bfe_u32 v4, v3, 2, 1
v_and_b32_e64 v5, 3, v3
v_lshl_add_u32 v4, v4, 2, v5
v_mul_u32_u24 v4, 1056, v4
v_bfe_u32 v6, v3, 3, 1
v_lshl_add_u32 v4, v6, 8, v4
v_and_b32 v6, 48, v3
v_add_u32 v239, v4, v6
v_bfe_u32 v4, v3, 2, 3
v_mul_u32_u24 v4, 1056, v4
v_lshrrev_b32_e64 v6, 5, v3
v_lshl_add_u32 v7, v6, 8, v4
v_lshl_add_u32 v240, v5, 3, v7
v_add_u32 v240, 8448, v240
v_lshrrev_b32_e64 v4, 2, v3
v_mul_u32_u24 v4, 1056, v4
v_lshl_add_u32 v4, v5, 4, v4
s_lshl_b32 s4, s40, 8
v_add_u32 v4, s4, v4
v_add_u32 v254, 84480, v4
v_cmp_eq_u32_e64 vcc, 0, v5
v_mov_b32 v4, 0x3f803f80
s_nop 0
v_cndmask_b32 v232, 0, v4, vcc
v_cndmask_b32 v233, 0, v4, vcc
v_cndmask_b32 v234, 0, v4, vcc
v_cndmask_b32_e64 v235, 0, v4, vcc
v_lshl_add_u32 v221, v5, 4, v7
s_lshl_b32 s4, s40, 6
v_add_u32 v221, s4, v221
v_and_b32_e64 v4, 15, v3
v_bfe_u32 v5, v3, 1, 3
v_lshrrev_b32 v6, 4, v3
v_xor_b32 v5, v5, v6
v_lshlrev_b32_e64 v4, 7, v4
v_lshl_add_u32 v216, v5, 4, v4
v_xor_b32 v217, 64, v216
v_add_u32 v218, 0, v216
v_add_u32 v220, 16896, v221
s_waitcnt vmcnt(8)
s_barrier
ds_read_b64_tr_b16 v[144:145], v220 offset:0
ds_read_b64_tr_b16 v[146:147], v220 offset:512
ds_read_b64_tr_b16 v[148:149], v220 offset:8
ds_read_b64_tr_b16 v[150:151], v220 offset:520
ds_read_b128 v[176:179], v218 offset:0
ds_read_b128 v[180:183], v218 offset:2048
ds_read_b128 v[184:187], v218 offset:4096
ds_read_b128 v[188:191], v218 offset:6144
ds_read_b128 v[192:195], v218 offset:8192
ds_read_b128 v[196:199], v218 offset:10240
ds_read_b128 v[200:203], v218 offset:12288
ds_read_b128 v[204:207], v218 offset:14336
v_add_u32 v219, 0, v217
s_waitcnt lgkmcnt(0)
v_mfma_f32_16x16x32_bf16 v[0:3], v[144:147], v[176:179], 0
ds_read_b64_tr_b16 v[152:153], v220 offset:8448
s_add_u32 m0, s97, 67584
ds_read_b64_tr_b16 v[154:155], v220 offset:8960
v_mfma_f32_16x16x32_bf16 v[4:7], v[148:151], v[176:179], 0
s_nop 0
s_add_u32 s96, s56, s62
ds_read_b64_tr_b16 v[156:157], v220 offset:8456
buffer_load_dwordx4 v208, s[16:19], s96 offen offset:0  lds
v_mfma_f32_16x16x32_bf16 v[12:15], v[148:151], v[180:183], 0
ds_read_b64_tr_b16 v[158:159], v220 offset:8968
buffer_load_dwordx4 v209, s[16:19], s96 offen offset:1024  lds
v_mfma_f32_16x16x32_bf16 v[8:11], v[144:147], v[180:183], 0
ds_read_b128 v[96:99], v219 offset:0
buffer_load_dwordx4 v210, s[16:19], s96 offen offset:2048  lds
ds_read_b128 v[100:103], v219 offset:2048
v_mfma_f32_16x16x32_bf16 v[16:19], v[144:147], v[184:187], 0
buffer_load_dwordx4 v211, s[16:19], s96 offen offset:3072  lds
ds_read_b128 v[104:107], v219 offset:4096
v_mfma_f32_16x16x32_bf16 v[20:23], v[148:151], v[184:187], 0
s_add_u32 s62, s62, 128
ds_read_b128 v[108:111], v219 offset:6144
s_and_b32 s62, s62, 1023
v_mfma_f32_16x16x32_bf16 v[28:31], v[148:151], v[188:191], 0
ds_read_b128 v[112:115], v219 offset:8192
s_add_u32 m0, s47, 84480
v_mfma_f32_16x16x32_bf16 v[24:27], v[144:147], v[188:191], 0
ds_read_b128 v[116:119], v219 offset:10240
s_add_u32 s96, s57, s63
s_nop 0
ds_read_b128 v[120:123], v219 offset:12288
v_mfma_f32_16x16x32_bf16 v[32:35], v[144:147], v[192:195], 0
buffer_load_dwordx4 v212, s[20:23], s96 offen offset:0  lds
ds_read_b128 v[124:127], v219 offset:14336
v_mfma_f32_16x16x32_bf16 v[36:39], v[148:151], v[192:195], 0
buffer_load_dwordx4 v213, s[20:23], s96 offen offset:1056  lds
buffer_load_dwordx4 v214, s[20:23], s96 offen offset:2112  lds
buffer_load_dwordx4 v215, s[20:23], s96 offen offset:3168  lds
v_mfma_f32_16x16x32_bf16 v[44:47], v[148:151], v[196:199], 0
s_add_u32 s63, s63, 524288
s_and_b32 s63, s63, 4194303
v_mfma_f32_16x16x32_bf16 v[40:43], v[144:147], v[196:199], 0
v_mfma_f32_16x16x32_bf16 v[48:51], v[144:147], v[200:203], 0
v_mfma_f32_16x16x32_bf16 v[52:55], v[148:151], v[200:203], 0
v_mfma_f32_16x16x32_bf16 v[60:63], v[148:151], v[204:207], 0
v_mfma_f32_16x16x32_bf16 v[56:59], v[144:147], v[204:207], 0
v_add_u32 v218, 33792, v216
v_add_u32 v220, 50688, v221
s_waitcnt vmcnt(8) lgkmcnt(0)
s_barrier
v_mfma_f32_16x16x32_bf16 v[0:3], v[152:155], v[96:99], v[0:3]
ds_read_b64_tr_b16 v[144:145], v220 offset:0
ds_read_b64_tr_b16 v[146:147], v220 offset:512
v_mfma_f32_16x16x32_bf16 v[4:7], v[156:159], v[96:99], v[4:7]
s_add_u32 m0, s97, 101376
ds_read_b64_tr_b16 v[148:149], v220 offset:8
v_mfma_f32_16x16x32_bf16 v[12:15], v[156:159], v[100:103], v[12:15]
ds_read_b64_tr_b16 v[150:151], v220 offset:520
s_add_u32 s96, s56, s62
s_nop 0
v_mfma_f32_16x16x32_bf16 v[8:11], v[152:155], v[100:103], v[8:11]
ds_read_b128 v[176:179], v218 offset:0
ds_read_b128 v[180:183], v218 offset:2048
v_mfma_f32_16x16x32_bf16 v[16:19], v[152:155], v[104:107], v[16:19]
buffer_load_dwordx4 v208, s[16:19], s96 offen offset:0  lds
ds_read_b128 v[184:187], v218 offset:4096
v_mfma_f32_16x16x32_bf16 v[20:23], v[156:159], v[104:107], v[20:23]
ds_read_b128 v[188:191], v218 offset:6144
v_mfma_f32_16x16x32_bf16 v[28:31], v[156:159], v[108:111], v[28:31]
buffer_load_dwordx4 v209, s[16:19], s96 offen offset:1024  lds
ds_read_b128 v[192:195], v218 offset:8192
v_mfma_f32_16x16x32_bf16 v[24:27], v[152:155], v[108:111], v[24:27]
ds_read_b128 v[196:199], v218 offset:10240
buffer_load_dwordx4 v210, s[16:19], s96 offen offset:2048  lds
v_mfma_f32_16x16x32_bf16 v[32:35], v[152:155], v[112:115], v[32:35]
ds_read_b128 v[200:203], v218 offset:12288
ds_read_b128 v[204:207], v218 offset:14336
v_mfma_f32_16x16x32_bf16 v[36:39], v[156:159], v[112:115], v[36:39]
buffer_load_dwordx4 v211, s[16:19], s96 offen offset:3072  lds
s_add_u32 s62, s62, 128
v_mfma_f32_16x16x32_bf16 v[44:47], v[156:159], v[116:119], v[44:47]
s_and_b32 s62, s62, 1023
v_mfma_f32_16x16x32_bf16 v[40:43], v[152:155], v[116:119], v[40:43]
v_mfma_f32_16x16x32_bf16 v[48:51], v[152:155], v[120:123], v[48:51]
v_mfma_f32_16x16x32_bf16 v[52:55], v[156:159], v[120:123], v[52:55]
v_mfma_f32_16x16x32_bf16 v[60:63], v[156:159], v[124:127], v[60:63]
v_mfma_f32_16x16x32_bf16 v[56:59], v[152:155], v[124:127], v[56:59]
v_add_u32 v219, 33792, v217
s_waitcnt lgkmcnt(0)
s_nop 0
v_mfma_f32_16x16x32_bf16 v[0:3], v[144:147], v[176:179], v[0:3]
ds_read_b64_tr_b16 v[152:153], v220 offset:8448
ds_read_b64_tr_b16 v[154:155], v220 offset:8960
v_mfma_f32_16x16x32_bf16 v[4:7], v[148:151], v[176:179], v[4:7]
s_add_u32 m0, s47, 118272
ds_read_b64_tr_b16 v[156:157], v220 offset:8456
v_mfma_f32_16x16x32_bf16 v[12:15], v[148:151], v[180:183], v[12:15]
ds_read_b64_tr_b16 v[158:159], v220 offset:8968
s_add_u32 s96, s57, s63
s_nop 0
v_mfma_f32_16x16x32_bf16 v[8:11], v[144:147], v[180:183], v[8:11]
ds_read_b128 v[96:99], v219 offset:0
ds_read_b128 v[100:103], v219 offset:2048
v_mfma_f32_16x16x32_bf16 v[16:19], v[144:147], v[184:187], v[16:19]
buffer_load_dwordx4 v212, s[20:23], s96 offen offset:0  lds
ds_read_b128 v[104:107], v219 offset:4096
v_mfma_f32_16x16x32_bf16 v[20:23], v[148:151], v[184:187], v[20:23]
ds_read_b128 v[108:111], v219 offset:6144
v_mfma_f32_16x16x32_bf16 v[28:31], v[148:151], v[188:191], v[28:31]
buffer_load_dwordx4 v213, s[20:23], s96 offen offset:1056  lds
ds_read_b128 v[112:115], v219 offset:8192
v_mfma_f32_16x16x32_bf16 v[24:27], v[144:147], v[188:191], v[24:27]
ds_read_b128 v[116:119], v219 offset:10240
buffer_load_dwordx4 v214, s[20:23], s96 offen offset:2112  lds
v_mfma_f32_16x16x32_bf16 v[32:35], v[144:147], v[192:195], v[32:35]
ds_read_b128 v[120:123], v219 offset:12288
ds_read_b128 v[124:127], v219 offset:14336
v_mfma_f32_16x16x32_bf16 v[36:39], v[148:151], v[192:195], v[36:39]
buffer_load_dwordx4 v215, s[20:23], s96 offen offset:3168  lds
s_add_u32 s63, s63, 524288
v_mfma_f32_16x16x32_bf16 v[44:47], v[148:151], v[196:199], v[44:47]
s_and_b32 s63, s63, 4194303
v_mfma_f32_16x16x32_bf16 v[40:43], v[144:147], v[196:199], v[40:43]
v_mfma_f32_16x16x32_bf16 v[48:51], v[144:147], v[200:203], v[48:51]
v_mfma_f32_16x16x32_bf16 v[52:55], v[148:151], v[200:203], v[52:55]
v_mfma_f32_16x16x32_bf16 v[60:63], v[148:151], v[204:207], v[60:63]
v_mfma_f32_16x16x32_bf16 v[56:59], v[144:147], v[204:207], v[56:59]
v_add_u32 v218, 67584, v216
v_add_u32 v220, 84480, v221
s_waitcnt vmcnt(8) lgkmcnt(0)
s_barrier
v_mfma_f32_16x16x32_bf16 v[0:3], v[152:155], v[96:99], v[0:3]
ds_read_b64_tr_b16 v[144:145], v220 offset:0
ds_read_b64_tr_b16 v[146:147], v220 offset:512
v_mfma_f32_16x16x32_bf16 v[4:7], v[156:159], v[96:99], v[4:7]
s_add_u32 m0, s97, 135168
ds_read_b64_tr_b16 v[148:149], v220 offset:8
v_mfma_f32_16x16x32_bf16 v[12:15], v[156:159], v[100:103], v[12:15]
ds_read_b64_tr_b16 v[150:151], v220 offset:520
s_add_u32 s96, s56, s62
s_nop 0
v_mfma_f32_16x16x32_bf16 v[8:11], v[152:155], v[100:103], v[8:11]
ds_read_b128 v[176:179], v218 offset:0
ds_read_b128 v[180:183], v218 offset:2048
v_mfma_f32_16x16x32_bf16 v[16:19], v[152:155], v[104:107], v[16:19]
buffer_load_dwordx4 v208, s[16:19], s96 offen offset:0  lds
ds_read_b128 v[184:187], v218 offset:4096
v_mfma_f32_16x16x32_bf16 v[20:23], v[156:159], v[104:107], v[20:23]
ds_read_b128 v[188:191], v218 offset:6144
v_mfma_f32_16x16x32_bf16 v[28:31], v[156:159], v[108:111], v[28:31]
buffer_load_dwordx4 v209, s[16:19], s96 offen offset:1024  lds
ds_read_b128 v[192:195], v218 offset:8192
v_mfma_f32_16x16x32_bf16 v[24:27], v[152:155], v[108:111], v[24:27]
ds_read_b128 v[196:199], v218 offset:10240
buffer_load_dwordx4 v210, s[16:19], s96 offen offset:2048  lds
v_mfma_f32_16x16x32_bf16 v[32:35], v[152:155], v[112:115], v[32:35]
ds_read_b128 v[200:203], v218 offset:12288
ds_read_b128 v[204:207], v218 offset:14336
v_mfma_f32_16x16x32_bf16 v[36:39], v[156:159], v[112:115], v[36:39]
buffer_load_dwordx4 v211, s[16:19], s96 offen offset:3072  lds
s_add_u32 s62, s62, 128
v_mfma_f32_16x16x32_bf16 v[44:47], v[156:159], v[116:119], v[44:47]
s_and_b32 s62, s62, 1023
v_mfma_f32_16x16x32_bf16 v[40:43], v[152:155], v[116:119], v[40:43]
v_mfma_f32_16x16x32_bf16 v[48:51], v[152:155], v[120:123], v[48:51]
v_mfma_f32_16x16x32_bf16 v[52:55], v[156:159], v[120:123], v[52:55]
v_mfma_f32_16x16x32_bf16 v[60:63], v[156:159], v[124:127], v[60:63]
v_mfma_f32_16x16x32_bf16 v[56:59], v[152:155], v[124:127], v[56:59]
v_add_u32 v219, 67584, v217
s_waitcnt lgkmcnt(0)
s_nop 0
v_mfma_f32_16x16x32_bf16 v[0:3], v[144:147], v[176:179], v[0:3]
ds_read_b64_tr_b16 v[152:153], v220 offset:8448
ds_read_b64_tr_b16 v[154:155], v220 offset:8960
v_mfma_f32_16x16x32_bf16 v[4:7], v[148:151], v[176:179], v[4:7]
s_nop 0
s_add_u32 m0, s47, 0
ds_read_b64_tr_b16 v[156:157], v220 offset:8456
v_mfma_f32_16x16x32_bf16 v[12:15], v[148:151], v[180:183], v[12:15]
ds_read_b64_tr_b16 v[158:159], v220 offset:8968
s_add_u32 s96, s57, s63
s_nop 0
v_mfma_f32_16x16x32_bf16 v[8:11], v[144:147], v[180:183], v[8:11]
ds_read_b128 v[96:99], v219 offset:0
ds_read_b128 v[100:103], v219 offset:2048
v_mfma_f32_16x16x32_bf16 v[16:19], v[144:147], v[184:187], v[16:19]
buffer_load_dwordx4 v212, s[20:23], s96 offen offset:0  lds
ds_read_b128 v[104:107], v219 offset:4096
v_mfma_f32_16x16x32_bf16 v[20:23], v[148:151], v[184:187], v[20:23]
ds_read_b128 v[108:111], v219 offset:6144
v_mfma_f32_16x16x32_bf16 v[28:31], v[148:151], v[188:191], v[28:31]
buffer_load_dwordx4 v213, s[20:23], s96 offen offset:1056  lds
ds_read_b128 v[112:115], v219 offset:8192
v_mfma_f32_16x16x32_bf16 v[24:27], v[144:147], v[188:191], v[24:27]
ds_read_b128 v[116:119], v219 offset:10240
buffer_load_dwordx4 v214, s[20:23], s96 offen offset:2112  lds
v_mfma_f32_16x16x32_bf16 v[32:35], v[144:147], v[192:195], v[32:35]
ds_read_b128 v[120:123], v219 offset:12288
ds_read_b128 v[124:127], v219 offset:14336
v_mfma_f32_16x16x32_bf16 v[36:39], v[148:151], v[192:195], v[36:39]
buffer_load_dwordx4 v215, s[20:23], s96 offen offset:3168  lds
s_add_u32 s63, s63, 524288
v_mfma_f32_16x16x32_bf16 v[44:47], v[148:151], v[196:199], v[44:47]
s_and_b32 s63, s63, 4194303
v_mfma_f32_16x16x32_bf16 v[40:43], v[144:147], v[196:199], v[40:43]
v_mfma_f32_16x16x32_bf16 v[48:51], v[144:147], v[200:203], v[48:51]
v_mfma_f32_16x16x32_bf16 v[52:55], v[148:151], v[200:203], v[52:55]
v_mfma_f32_16x16x32_bf16 v[60:63], v[148:151], v[204:207], v[60:63]
v_mfma_f32_16x16x32_bf16 v[56:59], v[144:147], v[204:207], v[56:59]
v_add_u32 v218, 101376, v216
v_add_u32 v220, 118272, v221
s_waitcnt vmcnt(8) lgkmcnt(0)
s_barrier
v_mfma_f32_16x16x32_bf16 v[0:3], v[152:155], v[96:99], v[0:3]
ds_read_b64_tr_b16 v[144:145], v220 offset:0
ds_read_b64_tr_b16 v[146:147], v220 offset:512
v_mfma_f32_16x16x32_bf16 v[4:7], v[156:159], v[96:99], v[4:7]
s_add_u32 m0, s97, 16896
ds_read_b64_tr_b16 v[148:149], v220 offset:8
v_mfma_f32_16x16x32_bf16 v[12:15], v[156:159], v[100:103], v[12:15]
ds_read_b64_tr_b16 v[150:151], v220 offset:520
s_add_u32 s96, s56, s62
s_nop 0
v_mfma_f32_16x16x32_bf16 v[8:11], v[152:155], v[100:103], v[8:11]
ds_read_b128 v[176:179], v218 offset:0
ds_read_b128 v[180:183], v218 offset:2048
v_mfma_f32_16x16x32_bf16 v[16:19], v[152:155], v[104:107], v[16:19]
buffer_load_dwordx4 v208, s[16:19], s96 offen offset:0  lds
ds_read_b128 v[184:187], v218 offset:4096
v_mfma_f32_16x16x32_bf16 v[20:23], v[156:159], v[104:107], v[20:23]
ds_read_b128 v[188:191], v218 offset:6144
v_mfma_f32_16x16x32_bf16 v[28:31], v[156:159], v[108:111], v[28:31]
buffer_load_dwordx4 v209, s[16:19], s96 offen offset:1024  lds
ds_read_b128 v[192:195], v218 offset:8192
v_mfma_f32_16x16x32_bf16 v[24:27], v[152:155], v[108:111], v[24:27]
ds_read_b128 v[196:199], v218 offset:10240
buffer_load_dwordx4 v210, s[16:19], s96 offen offset:2048  lds
v_mfma_f32_16x16x32_bf16 v[32:35], v[152:155], v[112:115], v[32:35]
ds_read_b128 v[200:203], v218 offset:12288
ds_read_b128 v[204:207], v218 offset:14336
v_mfma_f32_16x16x32_bf16 v[36:39], v[156:159], v[112:115], v[36:39]
buffer_load_dwordx4 v211, s[16:19], s96 offen offset:3072  lds
s_add_u32 s62, s62, 128
v_mfma_f32_16x16x32_bf16 v[44:47], v[156:159], v[116:119], v[44:47]
s_and_b32 s62, s62, 1023
v_mfma_f32_16x16x32_bf16 v[40:43], v[152:155], v[116:119], v[40:43]
v_mfma_f32_16x16x32_bf16 v[48:51], v[152:155], v[120:123], v[48:51]
v_mfma_f32_16x16x32_bf16 v[52:55], v[156:159], v[120:123], v[52:55]
v_mfma_f32_16x16x32_bf16 v[60:63], v[156:159], v[124:127], v[60:63]
v_mfma_f32_16x16x32_bf16 v[56:59], v[152:155], v[124:127], v[56:59]
v_add_u32 v219, 101376, v217
s_waitcnt lgkmcnt(0)
s_nop 0
v_mfma_f32_16x16x32_bf16 v[0:3], v[144:147], v[176:179], v[0:3]
ds_read_b64_tr_b16 v[152:153], v220 offset:8448
ds_read_b64_tr_b16 v[154:155], v220 offset:8960
v_mfma_f32_16x16x32_bf16 v[4:7], v[148:151], v[176:179], v[4:7]
s_add_u32 m0, s47, 33792
ds_read_b64_tr_b16 v[156:157], v220 offset:8456
v_mfma_f32_16x16x32_bf16 v[12:15], v[148:151], v[180:183], v[12:15]
ds_read_b64_tr_b16 v[158:159], v220 offset:8968
s_add_u32 s96, s57, s63
s_nop 0
v_mfma_f32_16x16x32_bf16 v[8:11], v[144:147], v[180:183], v[8:11]
ds_read_b128 v[96:99], v219 offset:0
ds_read_b128 v[100:103], v219 offset:2048
v_mfma_f32_16x16x32_bf16 v[16:19], v[144:147], v[184:187], v[16:19]
buffer_load_dwordx4 v212, s[20:23], s96 offen offset:0  lds
ds_read_b128 v[104:107], v219 offset:4096
v_mfma_f32_16x16x32_bf16 v[20:23], v[148:151], v[184:187], v[20:23]
ds_read_b128 v[108:111], v219 offset:6144
v_mfma_f32_16x16x32_bf16 v[28:31], v[148:151], v[188:191], v[28:31]
buffer_load_dwordx4 v213, s[20:23], s96 offen offset:1056  lds
ds_read_b128 v[112:115], v219 offset:8192
v_mfma_f32_16x16x32_bf16 v[24:27], v[144:147], v[188:191], v[24:27]
ds_read_b128 v[116:119], v219 offset:10240
buffer_load_dwordx4 v214, s[20:23], s96 offen offset:2112  lds
v_mfma_f32_16x16x32_bf16 v[32:35], v[144:147], v[192:195], v[32:35]
ds_read_b128 v[120:123], v219 offset:12288
ds_read_b128 v[124:127], v219 offset:14336
v_mfma_f32_16x16x32_bf16 v[36:39], v[148:151], v[192:195], v[36:39]
buffer_load_dwordx4 v215, s[20:23], s96 offen offset:3168  lds
s_add_u32 s63, s63, 524288
v_mfma_f32_16x16x32_bf16 v[44:47], v[148:151], v[196:199], v[44:47]
s_and_b32 s63, s63, 4194303
v_mfma_f32_16x16x32_bf16 v[40:43], v[144:147], v[196:199], v[40:43]
v_mfma_f32_16x16x32_bf16 v[48:51], v[144:147], v[200:203], v[48:51]
v_mfma_f32_16x16x32_bf16 v[52:55], v[148:151], v[200:203], v[52:55]
v_mfma_f32_16x16x32_bf16 v[60:63], v[148:151], v[204:207], v[60:63]
v_mfma_f32_16x16x32_bf16 v[56:59], v[144:147], v[204:207], v[56:59]
v_add_u32 v218, 135168, v216
v_add_u32_e64 v220, 0, v221
s_waitcnt vmcnt(8) lgkmcnt(0)
s_barrier
v_mfma_f32_16x16x32_bf16 v[0:3], v[152:155], v[96:99], v[0:3]
ds_read_b64_tr_b16 v[144:145], v220 offset:0
ds_read_b64_tr_b16 v[146:147], v220 offset:512
v_mfma_f32_16x16x32_bf16 v[4:7], v[156:159], v[96:99], v[4:7]
s_add_u32 m0, s97, 50688
ds_read_b64_tr_b16 v[148:149], v220 offset:8
v_mfma_f32_16x16x32_bf16 v[12:15], v[156:159], v[100:103], v[12:15]
ds_read_b64_tr_b16 v[150:151], v220 offset:520
s_add_u32 s96, s56, s62
s_nop 0
v_mfma_f32_16x16x32_bf16 v[8:11], v[152:155], v[100:103], v[8:11]
ds_read_b128 v[176:179], v218 offset:0
ds_read_b128 v[180:183], v218 offset:2048
v_mfma_f32_16x16x32_bf16 v[16:19], v[152:155], v[104:107], v[16:19]
buffer_load_dwordx4 v208, s[16:19], s96 offen offset:0  lds
ds_read_b128 v[184:187], v218 offset:4096
v_mfma_f32_16x16x32_bf16 v[20:23], v[156:159], v[104:107], v[20:23]
ds_read_b128 v[188:191], v218 offset:6144
v_mfma_f32_16x16x32_bf16 v[28:31], v[156:159], v[108:111], v[28:31]
buffer_load_dwordx4 v209, s[16:19], s96 offen offset:1024  lds
ds_read_b128 v[192:195], v218 offset:8192
v_mfma_f32_16x16x32_bf16 v[24:27], v[152:155], v[108:111], v[24:27]
ds_read_b128 v[196:199], v218 offset:10240
buffer_load_dwordx4 v210, s[16:19], s96 offen offset:2048  lds
v_mfma_f32_16x16x32_bf16 v[32:35], v[152:155], v[112:115], v[32:35]
ds_read_b128 v[200:203], v218 offset:12288
ds_read_b128 v[204:207], v218 offset:14336
v_mfma_f32_16x16x32_bf16 v[36:39], v[156:159], v[112:115], v[36:39]
buffer_load_dwordx4 v211, s[16:19], s96 offen offset:3072  lds
s_add_u32 s62, s62, 128
v_mfma_f32_16x16x32_bf16 v[44:47], v[156:159], v[116:119], v[44:47]
s_and_b32 s62, s62, 1023
v_mfma_f32_16x16x32_bf16 v[40:43], v[152:155], v[116:119], v[40:43]
v_mfma_f32_16x16x32_bf16 v[48:51], v[152:155], v[120:123], v[48:51]
v_mfma_f32_16x16x32_bf16 v[52:55], v[156:159], v[120:123], v[52:55]
v_mfma_f32_16x16x32_bf16 v[60:63], v[156:159], v[124:127], v[60:63]
v_mfma_f32_16x16x32_bf16 v[56:59], v[152:155], v[124:127], v[56:59]
v_add_u32 v219, 135168, v217
s_waitcnt lgkmcnt(0)
s_nop 0
v_mfma_f32_16x16x32_bf16 v[0:3], v[144:147], v[176:179], v[0:3]
ds_read_b64_tr_b16 v[152:153], v220 offset:8448
ds_read_b64_tr_b16 v[154:155], v220 offset:8960
v_mfma_f32_16x16x32_bf16 v[4:7], v[148:151], v[176:179], v[4:7]
s_add_u32 m0, s47, 67584
ds_read_b64_tr_b16 v[156:157], v220 offset:8456
v_mfma_f32_16x16x32_bf16 v[12:15], v[148:151], v[180:183], v[12:15]
ds_read_b64_tr_b16 v[158:159], v220 offset:8968
s_add_u32 s96, s57, s63
s_nop 0
v_mfma_f32_16x16x32_bf16 v[8:11], v[144:147], v[180:183], v[8:11]
ds_read_b128 v[96:99], v219 offset:0
ds_read_b128 v[100:103], v219 offset:2048
v_mfma_f32_16x16x32_bf16 v[16:19], v[144:147], v[184:187], v[16:19]
buffer_load_dwordx4 v212, s[20:23], s96 offen offset:0  lds
ds_read_b128 v[104:107], v219 offset:4096
v_mfma_f32_16x16x32_bf16 v[20:23], v[148:151], v[184:187], v[20:23]
ds_read_b128 v[108:111], v219 offset:6144
v_mfma_f32_16x16x32_bf16 v[28:31], v[148:151], v[188:191], v[28:31]
buffer_load_dwordx4 v213, s[20:23], s96 offen offset:1056  lds
ds_read_b128 v[112:115], v219 offset:8192
v_mfma_f32_16x16x32_bf16 v[24:27], v[144:147], v[188:191], v[24:27]
ds_read_b128 v[116:119], v219 offset:10240
buffer_load_dwordx4 v214, s[20:23], s96 offen offset:2112  lds
v_mfma_f32_16x16x32_bf16 v[32:35], v[144:147], v[192:195], v[32:35]
ds_read_b128 v[120:123], v219 offset:12288
ds_read_b128 v[124:127], v219 offset:14336
v_mfma_f32_16x16x32_bf16 v[36:39], v[148:151], v[192:195], v[36:39]
buffer_load_dwordx4 v215, s[20:23], s96 offen offset:3168  lds
s_add_u32 s63, s63, 524288
v_mfma_f32_16x16x32_bf16 v[44:47], v[148:151], v[196:199], v[44:47]
s_and_b32 s63, s63, 4194303
v_mfma_f32_16x16x32_bf16 v[40:43], v[144:147], v[196:199], v[40:43]
v_mfma_f32_16x16x32_bf16 v[48:51], v[144:147], v[200:203], v[48:51]
v_mfma_f32_16x16x32_bf16 v[52:55], v[148:151], v[200:203], v[52:55]
v_mfma_f32_16x16x32_bf16 v[60:63], v[148:151], v[204:207], v[60:63]
v_mfma_f32_16x16x32_bf16 v[56:59], v[144:147], v[204:207], v[56:59]
v_add_u32 v218, 16896, v216
v_add_u32 v220, 33792, v221
s_waitcnt vmcnt(8) lgkmcnt(0)
s_barrier
v_mfma_f32_16x16x32_bf16 v[0:3], v[152:155], v[96:99], v[0:3]
ds_read_b64_tr_b16 v[144:145], v220 offset:0
ds_read_b64_tr_b16 v[146:147], v220 offset:512
v_mfma_f32_16x16x32_bf16 v[4:7], v[156:159], v[96:99], v[4:7]
s_add_u32 m0, s97, 84480
ds_read_b64_tr_b16 v[148:149], v220 offset:8
v_mfma_f32_16x16x32_bf16 v[12:15], v[156:159], v[100:103], v[12:15]
ds_read_b64_tr_b16 v[150:151], v220 offset:520
s_add_u32 s96, s56, s62
s_nop 0
v_mfma_f32_16x16x32_bf16 v[8:11], v[152:155], v[100:103], v[8:11]
ds_read_b128 v[176:179], v218 offset:0
ds_read_b128 v[180:183], v218 offset:2048
v_mfma_f32_16x16x32_bf16 v[16:19], v[152:155], v[104:107], v[16:19]
buffer_load_dwordx4 v208, s[16:19], s96 offen offset:0  lds
ds_read_b128 v[184:187], v218 offset:4096
v_mfma_f32_16x16x32_bf16 v[20:23], v[156:159], v[104:107], v[20:23]
ds_read_b128 v[188:191], v218 offset:6144
v_mfma_f32_16x16x32_bf16 v[28:31], v[156:159], v[108:111], v[28:31]
buffer_load_dwordx4 v209, s[16:19], s96 offen offset:1024  lds
ds_read_b128 v[192:195], v218 offset:8192
v_mfma_f32_16x16x32_bf16 v[24:27], v[152:155], v[108:111], v[24:27]
ds_read_b128 v[196:199], v218 offset:10240
buffer_load_dwordx4 v210, s[16:19], s96 offen offset:2048  lds
v_mfma_f32_16x16x32_bf16 v[32:35], v[152:155], v[112:115], v[32:35]
ds_read_b128 v[200:203], v218 offset:12288
ds_read_b128 v[204:207], v218 offset:14336
v_mfma_f32_16x16x32_bf16 v[36:39], v[156:159], v[112:115], v[36:39]
buffer_load_dwordx4 v211, s[16:19], s96 offen offset:3072  lds
s_add_u32 s62, s62, 128
v_mfma_f32_16x16x32_bf16 v[44:47], v[156:159], v[116:119], v[44:47]
s_and_b32 s62, s62, 1023
v_mfma_f32_16x16x32_bf16 v[40:43], v[152:155], v[116:119], v[40:43]
v_mfma_f32_16x16x32_bf16 v[48:51], v[152:155], v[120:123], v[48:51]
v_mfma_f32_16x16x32_bf16 v[52:55], v[156:159], v[120:123], v[52:55]
v_mfma_f32_16x16x32_bf16 v[60:63], v[156:159], v[124:127], v[60:63]
v_mfma_f32_16x16x32_bf16 v[56:59], v[152:155], v[124:127], v[56:59]
v_add_u32 v219, 16896, v217
s_waitcnt lgkmcnt(0)
s_nop 0
v_mfma_f32_16x16x32_bf16 v[0:3], v[144:147], v[176:179], v[0:3]
ds_read_b64_tr_b16 v[152:153], v220 offset:8448
ds_read_b64_tr_b16 v[154:155], v220 offset:8960
v_mfma_f32_16x16x32_bf16 v[4:7], v[148:151], v[176:179], v[4:7]
s_add_u32 m0, s47, 101376
ds_read_b64_tr_b16 v[156:157], v220 offset:8456
v_mfma_f32_16x16x32_bf16 v[12:15], v[148:151], v[180:183], v[12:15]
ds_read_b64_tr_b16 v[158:159], v220 offset:8968
s_add_u32 s96, s57, s63
s_nop 0
v_mfma_f32_16x16x32_bf16 v[8:11], v[144:147], v[180:183], v[8:11]
ds_read_b128 v[96:99], v219 offset:0
ds_read_b128 v[100:103], v219 offset:2048
v_mfma_f32_16x16x32_bf16 v[16:19], v[144:147], v[184:187], v[16:19]
buffer_load_dwordx4 v212, s[20:23], s96 offen offset:0  lds
ds_read_b128 v[104:107], v219 offset:4096
v_mfma_f32_16x16x32_bf16 v[20:23], v[148:151], v[184:187], v[20:23]
ds_read_b128 v[108:111], v219 offset:6144
v_mfma_f32_16x16x32_bf16 v[28:31], v[148:151], v[188:191], v[28:31]
buffer_load_dwordx4 v213, s[20:23], s96 offen offset:1056  lds
ds_read_b128 v[112:115], v219 offset:8192
v_mfma_f32_16x16x32_bf16 v[24:27], v[144:147], v[188:191], v[24:27]
ds_read_b128 v[116:119], v219 offset:10240
buffer_load_dwordx4 v214, s[20:23], s96 offen offset:2112  lds
v_mfma_f32_16x16x32_bf16 v[32:35], v[144:147], v[192:195], v[32:35]
ds_read_b128 v[120:123], v219 offset:12288
ds_read_b128 v[124:127], v219 offset:14336
v_mfma_f32_16x16x32_bf16 v[36:39], v[148:151], v[192:195], v[36:39]
buffer_load_dwordx4 v215, s[20:23], s96 offen offset:3168  lds
s_add_u32 s63, s63, 524288
v_mfma_f32_16x16x32_bf16 v[44:47], v[148:151], v[196:199], v[44:47]
s_and_b32 s63, s63, 4194303
v_mfma_f32_16x16x32_bf16 v[40:43], v[144:147], v[196:199], v[40:43]
v_mfma_f32_16x16x32_bf16 v[48:51], v[144:147], v[200:203], v[48:51]
v_mfma_f32_16x16x32_bf16 v[52:55], v[148:151], v[200:203], v[52:55]
v_mfma_f32_16x16x32_bf16 v[60:63], v[148:151], v[204:207], v[60:63]
v_mfma_f32_16x16x32_bf16 v[56:59], v[144:147], v[204:207], v[56:59]
v_add_u32 v218, 50688, v216
v_add_u32 v220, 67584, v221
s_waitcnt vmcnt(8) lgkmcnt(0)
s_barrier
v_mfma_f32_16x16x32_bf16 v[0:3], v[152:155], v[96:99], v[0:3]
ds_read_b64_tr_b16 v[144:145], v220 offset:0
ds_read_b64_tr_b16 v[146:147], v220 offset:512
v_mfma_f32_16x16x32_bf16 v[4:7], v[156:159], v[96:99], v[4:7]
ds_read_b64_tr_b16 v[148:149], v220 offset:8
v_mfma_f32_16x16x32_bf16 v[12:15], v[156:159], v[100:103], v[12:15]
ds_read_b64_tr_b16 v[150:151], v220 offset:520
v_mfma_f32_16x16x32_bf16 v[8:11], v[152:155], v[100:103], v[8:11]
ds_read_b128 v[176:179], v218 offset:0
v_mfma_f32_16x16x32_bf16 v[16:19], v[152:155], v[104:107], v[16:19]
ds_read_b128 v[180:183], v218 offset:2048
v_mfma_f32_16x16x32_bf16 v[20:23], v[156:159], v[104:107], v[20:23]
ds_read_b128 v[184:187], v218 offset:4096
v_mfma_f32_16x16x32_bf16 v[28:31], v[156:159], v[108:111], v[28:31]
ds_read_b128 v[188:191], v218 offset:6144
v_mfma_f32_16x16x32_bf16 v[24:27], v[152:155], v[108:111], v[24:27]
ds_read_b128 v[192:195], v218 offset:8192
v_mfma_f32_16x16x32_bf16 v[32:35], v[152:155], v[112:115], v[32:35]
ds_read_b128 v[196:199], v218 offset:10240
v_mfma_f32_16x16x32_bf16 v[36:39], v[156:159], v[112:115], v[36:39]
ds_read_b128 v[200:203], v218 offset:12288
v_mfma_f32_16x16x32_bf16 v[44:47], v[156:159], v[116:119], v[44:47]
ds_read_b128 v[204:207], v218 offset:14336
v_mfma_f32_16x16x32_bf16 v[40:43], v[152:155], v[116:119], v[40:43]
v_mfma_f32_16x16x32_bf16 v[48:51], v[152:155], v[120:123], v[48:51]
v_mfma_f32_16x16x32_bf16 v[52:55], v[156:159], v[120:123], v[52:55]
v_mfma_f32_16x16x32_bf16 v[60:63], v[156:159], v[124:127], v[60:63]
v_mfma_f32_16x16x32_bf16 v[56:59], v[152:155], v[124:127], v[56:59]
v_add_u32 v219, 50688, v217
s_waitcnt lgkmcnt(0)
s_nop 0
v_mfma_f32_16x16x32_bf16 v[0:3], v[144:147], v[176:179], v[0:3]
ds_read_b64_tr_b16 v[152:153], v220 offset:8448
ds_read_b64_tr_b16 v[154:155], v220 offset:8960
v_mfma_f32_16x16x32_bf16 v[4:7], v[148:151], v[176:179], v[4:7]
ds_read_b64_tr_b16 v[156:157], v220 offset:8456
v_mfma_f32_16x16x32_bf16 v[12:15], v[148:151], v[180:183], v[12:15]
ds_read_b64_tr_b16 v[158:159], v220 offset:8968
v_mfma_f32_16x16x32_bf16 v[8:11], v[144:147], v[180:183], v[8:11]
ds_read_b128 v[96:99], v219 offset:0
v_mfma_f32_16x16x32_bf16 v[16:19], v[144:147], v[184:187], v[16:19]
ds_read_b128 v[100:103], v219 offset:2048
v_mfma_f32_16x16x32_bf16 v[20:23], v[148:151], v[184:187], v[20:23]
ds_read_b128 v[104:107], v219 offset:4096
v_mfma_f32_16x16x32_bf16 v[28:31], v[148:151], v[188:191], v[28:31]
ds_read_b128 v[108:111], v219 offset:6144
v_mfma_f32_16x16x32_bf16 v[24:27], v[144:147], v[188:191], v[24:27]
ds_read_b128 v[112:115], v219 offset:8192
v_mfma_f32_16x16x32_bf16 v[32:35], v[144:147], v[192:195], v[32:35]
ds_read_b128 v[116:119], v219 offset:10240
v_mfma_f32_16x16x32_bf16 v[36:39], v[148:151], v[192:195], v[36:39]
ds_read_b128 v[120:123], v219 offset:12288
v_mfma_f32_16x16x32_bf16 v[44:47], v[148:151], v[196:199], v[44:47]
ds_read_b128 v[124:127], v219 offset:14336
v_mfma_f32_16x16x32_bf16 v[40:43], v[144:147], v[196:199], v[40:43]
v_mfma_f32_16x16x32_bf16 v[48:51], v[144:147], v[200:203], v[48:51]
v_mfma_f32_16x16x32_bf16 v[52:55], v[148:151], v[200:203], v[52:55]
v_mfma_f32_16x16x32_bf16 v[60:63], v[148:151], v[204:207], v[60:63]
v_mfma_f32_16x16x32_bf16 v[56:59], v[144:147], v[204:207], v[56:59]
v_add_u32 v218, 84480, v216
v_add_u32 v220, 101376, v221
s_waitcnt vmcnt(0) lgkmcnt(0)
s_barrier
v_mfma_f32_16x16x32_bf16 v[0:3], v[152:155], v[96:99], v[0:3]
ds_read_b64_tr_b16 v[144:145], v220 offset:0
ds_read_b64_tr_b16 v[146:147], v220 offset:512
v_mfma_f32_16x16x32_bf16 v[4:7], v[156:159], v[96:99], v[4:7]
ds_read_b64_tr_b16 v[148:149], v220 offset:8
v_mfma_f32_16x16x32_bf16 v[12:15], v[156:159], v[100:103], v[12:15]
ds_read_b64_tr_b16 v[150:151], v220 offset:520
v_mfma_f32_16x16x32_bf16 v[8:11], v[152:155], v[100:103], v[8:11]
ds_read_b128 v[176:179], v218 offset:0
v_mfma_f32_16x16x32_bf16 v[16:19], v[152:155], v[104:107], v[16:19]
ds_read_b128 v[180:183], v218 offset:2048
v_mfma_f32_16x16x32_bf16 v[20:23], v[156:159], v[104:107], v[20:23]
ds_read_b128 v[184:187], v218 offset:4096
v_mfma_f32_16x16x32_bf16 v[28:31], v[156:159], v[108:111], v[28:31]
ds_read_b128 v[188:191], v218 offset:6144
v_mfma_f32_16x16x32_bf16 v[24:27], v[152:155], v[108:111], v[24:27]
ds_read_b128 v[192:195], v218 offset:8192
v_mfma_f32_16x16x32_bf16 v[32:35], v[152:155], v[112:115], v[32:35]
ds_read_b128 v[196:199], v218 offset:10240
v_mfma_f32_16x16x32_bf16 v[36:39], v[156:159], v[112:115], v[36:39]
ds_read_b128 v[200:203], v218 offset:12288
v_mfma_f32_16x16x32_bf16 v[44:47], v[156:159], v[116:119], v[44:47]
ds_read_b128 v[204:207], v218 offset:14336
v_mfma_f32_16x16x32_bf16 v[40:43], v[152:155], v[116:119], v[40:43]
v_mfma_f32_16x16x32_bf16 v[48:51], v[152:155], v[120:123], v[48:51]
v_mfma_f32_16x16x32_bf16 v[52:55], v[156:159], v[120:123], v[52:55]
v_mfma_f32_16x16x32_bf16 v[60:63], v[156:159], v[124:127], v[60:63]
v_mfma_f32_16x16x32_bf16 v[56:59], v[152:155], v[124:127], v[56:59]
v_add_u32 v219, 84480, v217
s_waitcnt lgkmcnt(0)
s_nop 0
v_mfma_f32_16x16x32_bf16 v[0:3], v[144:147], v[176:179], v[0:3]
ds_read_b64_tr_b16 v[152:153], v220 offset:8448
ds_read_b64_tr_b16 v[154:155], v220 offset:8960
v_mfma_f32_16x16x32_bf16 v[4:7], v[148:151], v[176:179], v[4:7]
ds_read_b64_tr_b16 v[156:157], v220 offset:8456
v_mfma_f32_16x16x32_bf16 v[12:15], v[148:151], v[180:183], v[12:15]
ds_read_b64_tr_b16 v[158:159], v220 offset:8968
v_mfma_f32_16x16x32_bf16 v[8:11], v[144:147], v[180:183], v[8:11]
ds_read_b128 v[96:99], v219 offset:0
v_mfma_f32_16x16x32_bf16 v[16:19], v[144:147], v[184:187], v[16:19]
ds_read_b128 v[100:103], v219 offset:2048
v_mfma_f32_16x16x32_bf16 v[20:23], v[148:151], v[184:187], v[20:23]
ds_read_b128 v[104:107], v219 offset:4096
v_mfma_f32_16x16x32_bf16 v[28:31], v[148:151], v[188:191], v[28:31]
ds_read_b128 v[108:111], v219 offset:6144
v_mfma_f32_16x16x32_bf16 v[24:27], v[144:147], v[188:191], v[24:27]
ds_read_b128 v[112:115], v219 offset:8192
v_mfma_f32_16x16x32_bf16 v[32:35], v[144:147], v[192:195], v[32:35]
ds_read_b128 v[116:119], v219 offset:10240
v_mfma_f32_16x16x32_bf16 v[36:39], v[148:151], v[192:195], v[36:39]
ds_read_b128 v[120:123], v219 offset:12288
v_mfma_f32_16x16x32_bf16 v[44:47], v[148:151], v[196:199], v[44:47]
ds_read_b128 v[124:127], v219 offset:14336
v_mfma_f32_16x16x32_bf16 v[40:43], v[144:147], v[196:199], v[40:43]
v_mfma_f32_16x16x32_bf16 v[48:51], v[144:147], v[200:203], v[48:51]
v_mfma_f32_16x16x32_bf16 v[52:55], v[148:151], v[200:203], v[52:55]
v_mfma_f32_16x16x32_bf16 v[60:63], v[148:151], v[204:207], v[60:63]
v_mfma_f32_16x16x32_bf16 v[56:59], v[144:147], v[204:207], v[56:59]
s_nop 0
s_waitcnt lgkmcnt(0)
v_mfma_f32_16x16x32_bf16 v[0:3], v[152:155], v[96:99], v[0:3]
v_mfma_f32_16x16x32_bf16 v[4:7], v[156:159], v[96:99], v[4:7]
v_mfma_f32_16x16x32_bf16 v[12:15], v[156:159], v[100:103], v[12:15]
v_mfma_f32_16x16x32_bf16 v[8:11], v[152:155], v[100:103], v[8:11]
v_mfma_f32_16x16x32_bf16 v[16:19], v[152:155], v[104:107], v[16:19]
v_mfma_f32_16x16x32_bf16 v[20:23], v[156:159], v[104:107], v[20:23]
v_mfma_f32_16x16x32_bf16 v[28:31], v[156:159], v[108:111], v[28:31]
v_mfma_f32_16x16x32_bf16 v[24:27], v[152:155], v[108:111], v[24:27]
v_mfma_f32_16x16x32_bf16 v[32:35], v[152:155], v[112:115], v[32:35]
v_mfma_f32_16x16x32_bf16 v[36:39], v[156:159], v[112:115], v[36:39]
v_mfma_f32_16x16x32_bf16 v[44:47], v[156:159], v[116:119], v[44:47]
v_mfma_f32_16x16x32_bf16 v[40:43], v[152:155], v[116:119], v[40:43]
v_mfma_f32_16x16x32_bf16 v[48:51], v[152:155], v[120:123], v[48:51]
v_mfma_f32_16x16x32_bf16 v[52:55], v[156:159], v[120:123], v[52:55]
v_mfma_f32_16x16x32_bf16 v[60:63], v[156:159], v[124:127], v[60:63]
v_mfma_f32_16x16x32_bf16 v[56:59], v[152:155], v[124:127], v[56:59]
s_nop 0
s_lshr_b32 s4, s2, 3
s_mul_i32 s5, s4, 3641
s_lshr_b32 s5, s5, 16
s_mul_i32 s5, s5, 18
s_sub_u32 s4, s4, s5
s_add_u32 s53, s4, 1
s_cmp_gt_u32 s53, 9
s_cselect_b32 s4, 18, 9
s_sub_u32 s4, s4, s53
s_mul_i32 s44, s4, 16896
s_mov_b32 s54, s44
v_mov_b32_e64 v246, 0
buffer_load_dword v247, v246, s[32:35], 0 offen sc1
s_lshl_b32 s4, s60, 7
s_add_u32 s4, s4, s61
s_lshl_b32 s4, s4, 13
s_lshl_b32 s5, s40, 11
s_add_u32 s4, s4, s5
s_nop 0
v_mov_b32 v248, 0x3e0293ee
v_mov_b32 v249, 0x3e0293ee
v_pk_mul_f32 v[0:1], v[248:249], v[0:1]
v_pk_mul_f32 v[2:3], v[248:249], v[2:3]
v_pk_mul_f32 v[4:5], v[248:249], v[4:5]
v_pk_mul_f32 v[6:7], v[248:249], v[6:7]
v_cvt_pk_bf16_f32 v144, v0, v1
v_cvt_pk_bf16_f32 v145, v2, v3
v_cvt_pk_bf16_f32 v146, v4, v5
v_cvt_pk_bf16_f32 v147, v6, v7
buffer_store_dwordx4 v[144:147], v238, s[36:39], s4 offen offset:0 sc1
v_pk_mul_f32 v[8:9], v[248:249], v[8:9]
v_pk_mul_f32 v[10:11], v[248:249], v[10:11]
v_pk_mul_f32 v[12:13], v[248:249], v[12:13]
v_pk_mul_f32 v[14:15], v[248:249], v[14:15]
v_cvt_pk_bf16_f32 v148, v8, v9
v_cvt_pk_bf16_f32 v149, v10, v11
v_cvt_pk_bf16_f32 v150, v12, v13
v_cvt_pk_bf16_f32 v151, v14, v15
buffer_store_dwordx4 v[148:151], v238, s[36:39], s4 offen offset:1024 sc1
s_add_u32 s4, s4, 262144
v_pk_mul_f32 v[16:17], v[248:249], v[16:17]
v_pk_mul_f32 v[18:19], v[248:249], v[18:19]
v_pk_mul_f32 v[20:21], v[248:249], v[20:21]
v_pk_mul_f32 v[22:23], v[248:249], v[22:23]
v_cvt_pk_bf16_f32 v152, v16, v17
v_cvt_pk_bf16_f32 v153, v18, v19
v_cvt_pk_bf16_f32 v154, v20, v21
v_cvt_pk_bf16_f32 v155, v22, v23
buffer_store_dwordx4 v[152:155], v238, s[36:39], s4 offen offset:0 sc1
v_pk_mul_f32 v[24:25], v[248:249], v[24:25]
v_pk_mul_f32 v[26:27], v[248:249], v[26:27]
v_pk_mul_f32 v[28:29], v[248:249], v[28:29]
v_pk_mul_f32 v[30:31], v[248:249], v[30:31]
v_cvt_pk_bf16_f32 v156, v24, v25
v_cvt_pk_bf16_f32 v157, v26, v27
v_cvt_pk_bf16_f32 v158, v28, v29
v_cvt_pk_bf16_f32 v159, v30, v31
buffer_store_dwordx4 v[156:159], v238, s[36:39], s4 offen offset:1024 sc1
s_add_u32 s4, s4, 262144
v_pk_mul_f32 v[32:33], v[248:249], v[32:33]
v_pk_mul_f32 v[34:35], v[248:249], v[34:35]
v_pk_mul_f32 v[36:37], v[248:249], v[36:37]
v_pk_mul_f32 v[38:39], v[248:249], v[38:39]
v_cvt_pk_bf16_f32 v160, v32, v33
v_cvt_pk_bf16_f32 v161, v34, v35
v_cvt_pk_bf16_f32 v162, v36, v37
v_cvt_pk_bf16_f32 v163, v38, v39
buffer_store_dwordx4 v[160:163], v238, s[36:39], s4 offen offset:0 sc1
v_pk_mul_f32 v[40:41], v[248:249], v[40:41]
v_pk_mul_f32 v[42:43], v[248:249], v[42:43]
v_pk_mul_f32 v[44:45], v[248:249], v[44:45]
v_pk_mul_f32 v[46:47], v[248:249], v[46:47]
v_cvt_pk_bf16_f32 v164, v40, v41
v_cvt_pk_bf16_f32 v165, v42, v43
v_cvt_pk_bf16_f32 v166, v44, v45
v_cvt_pk_bf16_f32 v167, v46, v47
buffer_store_dwordx4 v[164:167], v238, s[36:39], s4 offen offset:1024 sc1
s_add_u32 s4, s4, 262144
v_pk_mul_f32 v[48:49], v[248:249], v[48:49]
v_pk_mul_f32 v[50:51], v[248:249], v[50:51]
v_pk_mul_f32 v[52:53], v[248:249], v[52:53]
v_pk_mul_f32 v[54:55], v[248:249], v[54:55]
v_cvt_pk_bf16_f32 v168, v48, v49
v_cvt_pk_bf16_f32 v169, v50, v51
v_cvt_pk_bf16_f32 v170, v52, v53
v_cvt_pk_bf16_f32 v171, v54, v55
buffer_store_dwordx4 v[168:171], v238, s[36:39], s4 offen offset:0 sc1
v_pk_mul_f32 v[56:57], v[248:249], v[56:57]
v_pk_mul_f32 v[58:59], v[248:249], v[58:59]
v_pk_mul_f32 v[60:61], v[248:249], v[60:61]
v_pk_mul_f32 v[62:63], v[248:249], v[62:63]
v_cvt_pk_bf16_f32 v172, v56, v57
v_cvt_pk_bf16_f32 v173, v58, v59
v_cvt_pk_bf16_f32 v174, v60, v61
v_cvt_pk_bf16_f32 v175, v62, v63
buffer_store_dwordx4 v[172:175], v238, s[36:39], s4 offen offset:1024 sc1
s_barrier
s_add_u32 m0, s54, s47
s_cmp_eq_u32 s54, s0
s_cselect_b32 s45, s55, 16896
s_add_u32 s54, s54, s45
buffer_load_dwordx4 v236, s[8:11], s48 offen offset:0 nt lds
buffer_load_dwordx4 v237, s[8:11], s48 offen offset:1056 nt lds
buffer_load_dwordx4 v241, s[8:11], s48 offen offset:2112 nt lds
buffer_load_dwordx4 v252, s[8:11], s48 offen offset:3168 nt lds
s_add_u32 s48, s48, s50
s_add_u32 m0, s54, s47
s_cmp_eq_u32 s54, s0
s_cselect_b32 s45, s55, 16896
s_add_u32 s54, s54, s45
buffer_load_dwordx4 v236, s[8:11], s48 offen offset:0 nt lds
buffer_load_dwordx4 v237, s[8:11], s48 offen offset:1056 nt lds
buffer_load_dwordx4 v241, s[8:11], s48 offen offset:2112 nt lds
buffer_load_dwordx4 v252, s[8:11], s48 offen offset:3168 nt lds
s_add_u32 s48, s48, s50
s_lshl_b32 s4, s60, 3
s_and_b32 s5, s2, 7
s_add_u32 s4, s4, s5
s_lshl_b32 s4, s4, 7
s_add_u32 s4, s4, 33554432
v_add_u32 v239, s44, v239
v_add_u32_e64 v240, s44, v240
s_waitcnt vmcnt(8)
v_readfirstlane_b32 s5, v247
s_cmp_ge_u32 s5, 8
s_cbranch_scc1 L_initok
s_mov_b32 s3, 0x40000
L_spinIA:
buffer_load_dword v247, v246, s[32:35], 0 offen sc1
s_sub_u32 s3, s3, 1
s_cbranch_scc1 L_spinIA_x
s_waitcnt vmcnt(0)
v_readfirstlane_b32 s5, v247
s_cmp_lt_u32 s5, 8
s_cbranch_scc1 L_spinIA
L_spinIA_x:
L_initok:
v_mov_b32 v247, 1
s_mov_b64 exec, 1
buffer_atomic_add v247, v246, s[36:39], s4 offen sc1
s_mov_b64 exec, -1
s_add_u32 m0, s54, s47
s_cmp_eq_u32 s54, s0
s_cselect_b32 s45, s55, 16896
s_add_u32 s54, s54, s45
buffer_load_dwordx4 v236, s[8:11], s48 offen offset:0 nt lds
buffer_load_dwordx4 v237, s[8:11], s48 offen offset:1056 nt lds
buffer_load_dwordx4 v241, s[8:11], s48 offen offset:2112 nt lds
buffer_load_dwordx4 v252, s[8:11], s48 offen offset:3168 nt lds
s_add_u32 s48, s48, s50
s_add_u32 m0, s54, s47
s_cmp_eq_u32 s54, s0
s_cselect_b32 s45, s55, 16896
s_add_u32 s54, s54, s45
buffer_load_dwordx4 v236, s[8:11], s48 offen offset:0 nt lds
buffer_load_dwordx4 v237, s[8:11], s48 offen offset:1056 nt lds
buffer_load_dwordx4 v241, s[8:11], s48 offen offset:2112 nt lds
buffer_load_dwordx4 v252, s[8:11], s48 offen offset:3168 nt lds
s_add_u32 s48, s48, s50
s_add_u32 m0, s54, s47
s_cmp_eq_u32 s54, s0
s_cselect_b32 s45, s55, 16896
s_add_u32 s54, s54, s45
buffer_load_dwordx4 v236, s[8:11], s48 offen offset:0 nt lds
buffer_load_dwordx4 v237, s[8:11], s48 offen offset:1056 nt lds
buffer_load_dwordx4 v241, s[8:11], s48 offen offset:2112 nt lds
buffer_load_dwordx4 v252, s[8:11], s48 offen offset:3168 nt lds
s_add_u32 s48, s48, s50
s_add_u32 m0, s54, s47
s_cmp_eq_u32 s54, s0
s_cselect_b32 s45, s55, 16896
s_add_u32 s54, s54, s45
buffer_load_dwordx4 v236, s[8:11], s48 offen offset:0 nt lds
buffer_load_dwordx4 v237, s[8:11], s48 offen offset:1056 nt lds
buffer_load_dwordx4 v241, s[8:11], s48 offen offset:2112 nt lds
buffer_load_dwordx4 v252, s[8:11], s48 offen offset:3168 nt lds
s_add_u32 s48, s48, s50
s_mul_i32 s4, s41, 2
s_sub_u32 s1, 59, s4
s_mov_b32 s58, 0x24b2c991
s_mov_b32 s59, 0x49
s_lshl_b64 s[58:59], s[58:59], s53
s_min_u32 s1, s1, 63
s_bitset1_b64 s[58:59], s1
s_mov_b32 s56, 0x208101
s_mov_b32 s57, 0x0
s_lshl_b64 s[56:57], s[56:57], s53
s_mov_b32 s96, 3
v_mov_b32 v0, 0
v_mov_b32 v1, 0
v_mov_b32 v2, 0
v_mov_b32 v3, 0
v_mov_b32 v4, 0
v_mov_b32 v5, 0
v_mov_b32 v6, 0
v_mov_b32 v7, 0
v_mov_b32 v8, 0
v_mov_b32 v9, 0
v_mov_b32 v10, 0
v_mov_b32 v11, 0
v_mov_b32 v12, 0
v_mov_b32 v13, 0
v_mov_b32 v14, 0
v_mov_b32 v15, 0
v_mov_b32 v16, 0
v_mov_b32 v17, 0
v_mov_b32 v18, 0
v_mov_b32 v19, 0
v_mov_b32 v20, 0
v_mov_b32 v21, 0
v_mov_b32 v22, 0
v_mov_b32 v23, 0
v_mov_b32 v24, 0
v_mov_b32 v25, 0
v_mov_b32 v26, 0
v_mov_b32 v27, 0
v_mov_b32 v28, 0
v_mov_b32 v29, 0
v_mov_b32 v30, 0
v_mov_b32 v31, 0
v_mov_b32 v32, 0
v_mov_b32 v33, 0
v_mov_b32 v34, 0
v_mov_b32 v35, 0
v_mov_b32 v36, 0
v_mov_b32 v37, 0
v_mov_b32 v38, 0
v_mov_b32 v39, 0
v_mov_b32 v40, 0
v_mov_b32 v41, 0
v_mov_b32 v42, 0
v_mov_b32 v43, 0
v_mov_b32 v44, 0
v_mov_b32 v45, 0
v_mov_b32 v46, 0
v_mov_b32 v47, 0
v_mov_b32 v48, 0
v_mov_b32 v49, 0
v_mov_b32 v50, 0
v_mov_b32 v51, 0
v_mov_b32 v52, 0
v_mov_b32 v53, 0
v_mov_b32 v54, 0
v_mov_b32 v55, 0
v_mov_b32 v56, 0
v_mov_b32 v57, 0
v_mov_b32 v58, 0
v_mov_b32 v59, 0
v_mov_b32 v60, 0
v_mov_b32 v61, 0
v_mov_b32 v62, 0
v_mov_b32 v63, 0
v_mov_b32 v176, 0
v_mov_b32 v177, 0
v_mov_b32 v178, 0
v_mov_b32 v179, 0
v_mov_b32 v180, 0
v_mov_b32 v181, 0
v_mov_b32 v182, 0
v_mov_b32 v183, 0
v_mov_b32 v184, 0
v_mov_b32 v185, 0
v_mov_b32 v186, 0
v_mov_b32 v187, 0
v_mov_b32 v188, 0
v_mov_b32 v189, 0
v_mov_b32 v190, 0
v_mov_b32 v191, 0
v_mov_b32 v192, 0
v_mov_b32 v193, 0
v_mov_b32 v194, 0
v_mov_b32 v195, 0
v_mov_b32 v196, 0
v_mov_b32 v197, 0
v_mov_b32 v198, 0
v_mov_b32 v199, 0
v_mov_b32 v200, 0
v_mov_b32 v201, 0
v_mov_b32 v202, 0
v_mov_b32 v203, 0
v_mov_b32 v204, 0
v_mov_b32 v205, 0
v_mov_b32 v206, 0
v_mov_b32 v207, 0
v_mov_b32 v136, 0
v_mov_b32 v137, 0
v_mov_b32 v138, 0
v_mov_b32 v139, 0
v_mov_b32 v140, 0
v_mov_b32 v141, 0
v_mov_b32 v142, 0
v_mov_b32 v143, 0
v_mov_b32 v216, 0
v_mov_b32 v217, 0
v_mov_b32 v218, 0
v_mov_b32 v219, 0
v_mov_b32 v220, 0
v_mov_b32 v221, 0
v_mov_b32 v222, 0
v_mov_b32_e64 v223, 0
L_join:
s_mov_b32 s63, 0x40004000
s_ff1_i32_b64 s53, s[58:59]
s_lshl_b32 s4, s43, 1
s_add_u32 s4, s4, s41
s_lshl_b32 s4, s4, 18
s_lshl_b32 s5, s40, 12
s_add_u32 s60, s4, s5
s_mov_b32 s61, 0
s_mov_b32 s62, 0
s_cmp_lg_u32 s40, 0
s_cbranch_scc1 L_qwait
s_lshr_b32 s4, s42, 2
s_lshl_b32 s4, s4, 3
s_add_u32 s4, s4, s43
s_lshl_b32 s4, s4, 7
s_add_u32 s4, s4, 33554432
v_mov_b32_e64 v246, s4
s_mov_b32 s3, 0x40000
L_spinQ:
buffer_load_dword v247, v246, s[36:39], 0 offen sc1
s_sub_u32 s3, s3, 1
s_cbranch_scc1 L_spinQ_x
s_waitcnt vmcnt(0)
v_readfirstlane_b32 s4, v247
s_cmp_lt_u32 s4, 16
s_cbranch_scc1 L_spinQ
L_spinQ_x:
L_qwait:
s_barrier
s_lshl_b32 s4, s42, 3
s_add_u32 s4, s4, s43
s_lshl_b32 s4, s4, 2
s_add_u32 s4, s4, s40
s_lshl_b32 s4, s4, 13
s_add_u32 s5, s4, 4096
buffer_load_dwordx4 v[64:67], v238, s[36:39], s4 offen offset:0 sc1
buffer_load_dwordx4 v[68:71], v238, s[36:39], s4 offen offset:1024 sc1
buffer_load_dwordx4 v[72:75], v238, s[36:39], s4 offen offset:2048 sc1
buffer_load_dwordx4 v[76:79], v238, s[36:39], s4 offen offset:3072 sc1
buffer_load_dwordx4 v[80:83], v238, s[36:39], s5 offen offset:0 sc1
buffer_load_dwordx4 v[84:87], v238, s[36:39], s5 offen offset:1024 sc1
buffer_load_dwordx4 v[88:91], v238, s[36:39], s5 offen offset:2048 sc1
buffer_load_dwordx4 v[92:95], v238, s[36:39], s5 offen offset:3072 sc1
s_cmp_eq_u32 s96, 0
s_cbranch_scc1 L_q0
L_fillA2:
s_add_u32 m0, s54, s47
s_cmp_eq_u32 s54, s0
s_cselect_b32 s45, s55, 16896
s_add_u32 s54, s54, s45
s_nop 0
buffer_load_dwordx4 v236, s[8:11], s48 offen offset:0 nt lds
buffer_load_dwordx4 v237, s[8:11], s48 offen offset:1056 nt lds
buffer_load_dwordx4 v241, s[8:11], s48 offen offset:2112 nt lds
buffer_load_dwordx4 v252, s[8:11], s48 offen offset:3168 nt lds
s_add_u32 s48, s48, s50
s_sub_u32 s96, s96, 1
s_cmp_lg_u32 s96, 0
s_cbranch_scc1 L_fillA2
s_waitcnt vmcnt(12)
s_branch L_q1
L_q0:
s_waitcnt vmcnt(0)
L_q1:
s_barrier
L_q2:
ds_read_b128 v[144:147], v239 offset:0
ds_read_b128 v[148:151], v239 offset:512
ds_read_b128 v[152:155], v239 offset:64
ds_read_b128 v[156:159], v239 offset:576
ds_read_b128 v[160:163], v239 offset:128
ds_read_b128 v[164:167], v239 offset:640
ds_read_b128 v[168:171], v239 offset:192
ds_read_b128 v[172:175], v239 offset:704
s_cmp_eq_u32 s44, s0
s_cselect_b32 s45, s55, 16896
s_waitcnt lgkmcnt(7)
v_mfma_f32_16x16x32_bf16 v[96:99], v[144:147], v[64:67], 0
v_mfma_f32_16x16x32_bf16 v[100:103], v[144:147], v[68:71], 0
s_nop 0
s_waitcnt lgkmcnt(6)
v_mfma_f32_16x16x32_bf16 v[108:111], v[148:151], v[68:71], 0
v_mfma_f32_16x16x32_bf16 v[104:107], v[148:151], v[64:67], 0
s_nop 0
s_waitcnt lgkmcnt(5)
v_mfma_f32_16x16x32_bf16 v[96:99], v[152:155], v[72:75], v[96:99]
v_mfma_f32_16x16x32_bf16 v[100:103], v[152:155], v[76:79], v[100:103]
s_nop 0
s_waitcnt lgkmcnt(4)
v_mfma_f32_16x16x32_bf16 v[108:111], v[156:159], v[76:79], v[108:111]
v_mfma_f32_16x16x32_bf16 v[104:107], v[156:159], v[72:75], v[104:107]
s_nop 0
s_waitcnt lgkmcnt(3)
v_mfma_f32_16x16x32_bf16 v[96:99], v[160:163], v[80:83], v[96:99]
v_mfma_f32_16x16x32_bf16 v[100:103], v[160:163], v[84:87], v[100:103]
s_nop 0
s_waitcnt lgkmcnt(2)
v_mfma_f32_16x16x32_bf16 v[108:111], v[164:167], v[84:87], v[108:111]
v_mfma_f32_16x16x32_bf16 v[104:107], v[164:167], v[80:83], v[104:107]
s_nop 0
s_waitcnt lgkmcnt(1)
v_mfma_f32_16x16x32_bf16 v[96:99], v[168:171], v[88:91], v[96:99]
v_mfma_f32_16x16x32_bf16 v[100:103], v[168:171], v[92:95], v[100:103]
s_nop 0
s_waitcnt lgkmcnt(0)
v_mfma_f32_16x16x32_bf16 v[108:111], v[172:175], v[92:95], v[108:111]
v_mfma_f32_16x16x32_bf16 v[104:107], v[172:175], v[88:91], v[104:107]
v_add_u32 v239, s45, v239
v_add_u32 v240, s45, v240
s_mov_b32 s51, 0
s_nop 0
v_max3_f32 v246, v96, v97, v98
s_nop 2
v_max3_f32 v246, v246, v99, v104
v_max3_f32 v246, v246, v105, v106
v_max_f32 v246, v246, v107
v_mov_b32 v248, v246
s_nop 1
v_permlane32_swap_b32 v246, v248
v_max_f32 v246, v246, v248
v_mov_b32 v248, v246
s_nop 1
v_permlane16_swap_b32 v246, v248
v_max_f32 v246, v246, v248
v_add_f32 v246, 0x41200000, v246
v_max3_f32 v247, v100, v101, v102
v_max3_f32 v247, v247, v103, v108
v_max3_f32 v247, v247, v109, v110
v_max_f32 v247, v247, v111
v_mov_b32 v248, v247
s_nop 1
v_permlane32_swap_b32 v247, v248
v_max_f32 v247, v247, v248
v_mov_b32 v248, v247
s_nop 1
v_permlane16_swap_b32 v247, v248
v_max_f32_e64 v247, v247, v248
v_add_f32 v247, 0x41200000, v247
v_sub_f32 v208, 0, v246
v_sub_f32 v209, 0, v246
v_sub_f32 v210, 0, v246
v_sub_f32 v211, 0, v246
v_sub_f32 v212, 0, v247
v_sub_f32 v213, 0, v247
v_sub_f32 v214, 0, v247
v_sub_f32 v215, 0, v247
v_sub_f32 v96, v96, v246
v_sub_f32 v97, v97, v246
v_sub_f32 v98, v98, v246
v_sub_f32 v99, v99, v246
v_sub_f32 v100, v100, v247
v_sub_f32 v101, v101, v247
v_sub_f32 v102, v102, v247
v_sub_f32 v103, v103, v247
v_sub_f32 v104, v104, v246
v_sub_f32 v105, v105, v246
v_sub_f32 v106, v106, v246
v_sub_f32 v107, v107, v246
v_sub_f32 v108, v108, v247
v_sub_f32 v109, v109, v247
v_sub_f32 v110, v110, v247
v_sub_f32 v111, v111, v247
s_branch L_top1
.p2align 6
L_n0:
s_waitcnt vmcnt(12) lgkmcnt(0)
s_barrier
L_bk0:
v_mfma_f32_16x16x32_bf16 v[24:27], v[188:191], v[128:131], v[24:27]
ds_read_b128 v[144:147], v239 offset:0
ds_read_b128 v[148:151], v239 offset:512
v_mfma_f32_16x16x32_bf16 v[216:219], v[232:235], v[128:131], v[216:219]
buffer_load_dwordx4 v236, s[8:11], s48 offen offset:0 nt lds
ds_read_b128 v[152:155], v239 offset:64
v_mfma_f32_16x16x32_bf16 v[32:35], v[192:195], v[128:131], v[32:35]
ds_read_b128 v[156:159], v239 offset:576
buffer_load_dwordx4 v237, s[8:11], s48 offen offset:1056 nt lds
v_mfma_f32_16x16x32_bf16 v[36:39], v[192:195], v[132:135], v[36:39]
ds_read_b128 v[160:163], v239 offset:128
ds_read_b128 v[164:167], v239 offset:640
v_mfma_f32_16x16x32_bf16 v[44:47], v[196:199], v[132:135], v[44:47]
buffer_load_dwordx4 v241, s[8:11], s48 offen offset:2112 nt lds
ds_read_b128 v[168:171], v239 offset:192
v_mfma_f32_16x16x32_bf16 v[40:43], v[196:199], v[128:131], v[40:43]
ds_read_b128 v[172:175], v239 offset:704
buffer_load_dwordx4 v252, s[8:11], s48 offen offset:3168 nt lds
v_mfma_f32_16x16x32_bf16 v[48:51], v[200:203], v[128:131], v[48:51]
ds_read_b64_tr_b16 v[176:177], v240 offset:0
v_cvt_pk_bf16_f32 v136, v224, v225
v_mfma_f32_16x16x32_bf16 v[52:55], v[200:203], v[132:135], v[52:55]
s_cmp_eq_u32 s44, s0
v_exp_f32 v230, v118
v_mfma_f32_16x16x32_bf16 v[60:63], v[204:207], v[132:135], v[60:63]
s_cselect_b32 s45, s55, 16896
v_exp_f32_e64 v231, v119
v_mfma_f32_16x16x32_bf16 v[56:59], v[204:207], v[128:131], v[56:59]
ds_read_b64_tr_b16 v[178:179], v240 offset:512
v_cvt_pk_bf16_f32 v137, v226, v227
v_mfma_f32_16x16x32_bf16 v[220:223], v[232:235], v[132:135], v[220:223]
s_waitcnt lgkmcnt(2)
v_exp_f32 v224, v120
v_mfma_f32_16x16x32_bf16 v[96:99], v[144:147], v[64:67], v[208:211]
ds_read_b64_tr_b16 v[180:181], v240 offset:32
v_cvt_pk_bf16_f32 v140, v228, v229
v_mfma_f32_16x16x32_bf16 v[100:103], v[144:147], v[68:71], v[212:215]
ds_read_b64_tr_b16 v[182:183], v240 offset:544
v_exp_f32_e64 v225, v121
v_mfma_f32_16x16x32_bf16 v[108:111], v[148:151], v[68:71], v[212:215]
ds_read_b64_tr_b16 v[184:185], v240 offset:64
v_cvt_pk_bf16_f32 v141, v230, v231
v_mfma_f32_16x16x32_bf16 v[104:107], v[148:151], v[64:67], v[208:211]
s_add_u32 s48, s48, s50
v_exp_f32 v226, v122
v_mfma_f32_16x16x32_bf16 v[96:99], v[152:155], v[72:75], v[96:99]
ds_read_b64_tr_b16 v[186:187], v240 offset:576
v_or3_b32 v253, v136, v137, v140
v_mfma_f32_16x16x32_bf16 v[100:103], v[152:155], v[76:79], v[100:103]
ds_read_b64_tr_b16 v[188:189], v240 offset:96
v_cvt_pk_bf16_f32 v138, v224, v225
v_add_u32_e64 v239, s45, v239
v_mfma_f32_16x16x32_bf16 v[108:111], v[156:159], v[76:79], v[108:111]
ds_read_b64_tr_b16 v[190:191], v240 offset:608
v_exp_f32_e64 v227, v123
v_mfma_f32_16x16x32_bf16 v[104:107], v[156:159], v[72:75], v[104:107]
v_exp_f32_e64 v228, v124
v_mfma_f32_16x16x32_bf16 v[96:99], v[160:163], v[80:83], v[96:99]
ds_read_b64_tr_b16 v[192:193], v240 offset:128
v_cvt_pk_bf16_f32 v139, v226, v227
v_or3_b32 v253, v253, v141, v138
v_mfma_f32_16x16x32_bf16 v[100:103], v[160:163], v[84:87], v[100:103]
ds_read_b64_tr_b16 v[194:195], v240 offset:640
v_exp_f32_e64 v229, v125
v_mfma_f32_16x16x32_bf16 v[108:111], v[164:167], v[84:87], v[108:111]
ds_read_b64_tr_b16 v[196:197], v240 offset:160
v_exp_f32_e64 v230, v126
v_mfma_f32_16x16x32_bf16 v[104:107], v[164:167], v[80:83], v[104:107]
ds_read_b64_tr_b16 v[198:199], v240 offset:672
v_cvt_pk_bf16_f32 v142, v228, v229
v_mfma_f32_16x16x32_bf16 v[96:99], v[168:171], v[88:91], v[96:99]
ds_read_b64_tr_b16 v[200:201], v240 offset:192
v_exp_f32_e64 v231, v127
v_mfma_f32_16x16x32_bf16 v[100:103], v[168:171], v[92:95], v[100:103]
ds_read_b64_tr_b16 v[202:203], v240 offset:704
v_or3_b32 v253, v253, v139, v142
v_cvt_pk_bf16_f32 v143, v230, v231
v_mfma_f32_16x16x32_bf16 v[108:111], v[172:175], v[92:95], v[108:111]
ds_read_b64_tr_b16 v[204:205], v240 offset:224
v_bitop3_b32 v253, v253, v143, s63 bitop3:0xa8
v_mfma_f32_16x16x32_bf16 v[104:107], v[172:175], v[88:91], v[104:107]
ds_read_b64_tr_b16 v[206:207], v240 offset:736
v_cmp_ne_u32 vcc, 0, v253
v_add_u32 v240, s45, v240
L_be0:
s_cbranch_vccnz L_rare0
L_top1:
s_waitcnt lgkmcnt(8)
v_mfma_f32_16x16x32_bf16 v[0:3], v[176:179], v[136:139], v[0:3]
s_nop 0
s_add_u32 m0, s44, s47
v_mfma_f32_16x16x32_bf16 v[4:7], v[176:179], v[140:143], v[4:7]
s_add_u32 s44, s44, s45
v_exp_f32 v224, v96
v_mfma_f32_16x16x32_bf16 v[12:15], v[180:183], v[140:143], v[12:15]
s_add_u32 s51, s51, 1
v_exp_f32 v225, v97
v_mfma_f32_16x16x32_bf16 v[8:11], v[180:183], v[136:139], v[8:11]
v_exp_f32_e64 v226, v98
v_mfma_f32_16x16x32_bf16 v[16:19], v[184:187], v[136:139], v[16:19]
v_exp_f32_e64 v227, v99
v_mfma_f32_16x16x32_bf16 v[20:23], v[184:187], v[140:143], v[20:23]
v_exp_f32_e64 v228, v100
v_mfma_f32_16x16x32_bf16 v[28:31], v[188:191], v[140:143], v[28:31]
s_cmp_ge_u32 s51, s53
v_exp_f32_e64 v229, v101
s_cbranch_scc1 L_sp1
s_waitcnt vmcnt(12) lgkmcnt(0)
s_barrier
L_bk1:
v_mfma_f32_16x16x32_bf16 v[24:27], v[188:191], v[136:139], v[24:27]
ds_read_b128 v[144:147], v239 offset:0
ds_read_b128 v[148:151], v239 offset:512
v_mfma_f32_16x16x32_bf16 v[216:219], v[232:235], v[136:139], v[216:219]
buffer_load_dwordx4 v236, s[8:11], s48 offen offset:0 nt lds
ds_read_b128 v[152:155], v239 offset:64
v_mfma_f32_16x16x32_bf16 v[32:35], v[192:195], v[136:139], v[32:35]
ds_read_b128 v[156:159], v239 offset:576
buffer_load_dwordx4 v237, s[8:11], s48 offen offset:1056 nt lds
v_mfma_f32_16x16x32_bf16 v[36:39], v[192:195], v[140:143], v[36:39]
ds_read_b128 v[160:163], v239 offset:128
ds_read_b128 v[164:167], v239 offset:640
v_mfma_f32_16x16x32_bf16 v[44:47], v[196:199], v[140:143], v[44:47]
buffer_load_dwordx4 v241, s[8:11], s48 offen offset:2112 nt lds
ds_read_b128 v[168:171], v239 offset:192
v_mfma_f32_16x16x32_bf16 v[40:43], v[196:199], v[136:139], v[40:43]
ds_read_b128 v[172:175], v239 offset:704
buffer_load_dwordx4 v252, s[8:11], s48 offen offset:3168 nt lds
v_mfma_f32_16x16x32_bf16 v[48:51], v[200:203], v[136:139], v[48:51]
ds_read_b64_tr_b16 v[176:177], v240 offset:0
v_cvt_pk_bf16_f32 v128, v224, v225
v_mfma_f32_16x16x32_bf16 v[52:55], v[200:203], v[140:143], v[52:55]
s_cmp_eq_u32 s44, s0
v_exp_f32 v230, v102
v_mfma_f32_16x16x32_bf16 v[60:63], v[204:207], v[140:143], v[60:63]
s_cselect_b32 s45, s55, 16896
v_exp_f32_e64 v231, v103
v_mfma_f32_16x16x32_bf16 v[56:59], v[204:207], v[136:139], v[56:59]
ds_read_b64_tr_b16 v[178:179], v240 offset:512
v_cvt_pk_bf16_f32 v129, v226, v227
v_mfma_f32_16x16x32_bf16 v[220:223], v[232:235], v[140:143], v[220:223]
s_waitcnt lgkmcnt(2)
v_exp_f32 v224, v104
v_mfma_f32_16x16x32_bf16 v[112:115], v[144:147], v[64:67], v[208:211]
ds_read_b64_tr_b16 v[180:181], v240 offset:32
v_cvt_pk_bf16_f32 v132, v228, v229
v_mfma_f32_16x16x32_bf16 v[116:119], v[144:147], v[68:71], v[212:215]
ds_read_b64_tr_b16 v[182:183], v240 offset:544
v_exp_f32_e64 v225, v105
v_mfma_f32_16x16x32_bf16 v[124:127], v[148:151], v[68:71], v[212:215]
ds_read_b64_tr_b16 v[184:185], v240 offset:64
v_cvt_pk_bf16_f32 v133, v230, v231
v_mfma_f32_16x16x32_bf16 v[120:123], v[148:151], v[64:67], v[208:211]
s_add_u32 s48, s48, s50
v_exp_f32 v226, v106
v_mfma_f32_16x16x32_bf16 v[112:115], v[152:155], v[72:75], v[112:115]
ds_read_b64_tr_b16 v[186:187], v240 offset:576
v_or3_b32 v253, v128, v129, v132
v_mfma_f32_16x16x32_bf16 v[116:119], v[152:155], v[76:79], v[116:119]
ds_read_b64_tr_b16 v[188:189], v240 offset:96
v_cvt_pk_bf16_f32 v130, v224, v225
v_add_u32_e64 v239, s45, v239
v_mfma_f32_16x16x32_bf16 v[124:127], v[156:159], v[76:79], v[124:127]
ds_read_b64_tr_b16 v[190:191], v240 offset:608
v_exp_f32_e64 v227, v107
v_mfma_f32_16x16x32_bf16 v[120:123], v[156:159], v[72:75], v[120:123]
v_exp_f32_e64 v228, v108
v_mfma_f32_16x16x32_bf16 v[112:115], v[160:163], v[80:83], v[112:115]
ds_read_b64_tr_b16 v[192:193], v240 offset:128
v_cvt_pk_bf16_f32 v131, v226, v227
v_or3_b32 v253, v253, v133, v130
v_mfma_f32_16x16x32_bf16 v[116:119], v[160:163], v[84:87], v[116:119]
ds_read_b64_tr_b16 v[194:195], v240 offset:640
v_exp_f32_e64 v229, v109
v_mfma_f32_16x16x32_bf16 v[124:127], v[164:167], v[84:87], v[124:127]
ds_read_b64_tr_b16 v[196:197], v240 offset:160
v_exp_f32_e64 v230, v110
v_mfma_f32_16x16x32_bf16 v[120:123], v[164:167], v[80:83], v[120:123]
ds_read_b64_tr_b16 v[198:199], v240 offset:672
v_cvt_pk_bf16_f32 v134, v228, v229
v_mfma_f32_16x16x32_bf16 v[112:115], v[168:171], v[88:91], v[112:115]
ds_read_b64_tr_b16 v[200:201], v240 offset:192
v_exp_f32_e64 v231, v111
v_mfma_f32_16x16x32_bf16 v[116:119], v[168:171], v[92:95], v[116:119]
ds_read_b64_tr_b16 v[202:203], v240 offset:704
v_or3_b32 v253, v253, v131, v134
v_cvt_pk_bf16_f32 v135, v230, v231
v_mfma_f32_16x16x32_bf16 v[124:127], v[172:175], v[92:95], v[124:127]
ds_read_b64_tr_b16 v[204:205], v240 offset:224
v_bitop3_b32 v253, v253, v135, s63 bitop3:0xa8
v_mfma_f32_16x16x32_bf16 v[120:123], v[172:175], v[88:91], v[120:123]
ds_read_b64_tr_b16 v[206:207], v240 offset:736
v_cmp_ne_u32 vcc, 0, v253
v_add_u32 v240, s45, v240
L_be1:
s_cbranch_vccnz L_rare1
L_top0:
s_waitcnt lgkmcnt(8)
v_mfma_f32_16x16x32_bf16 v[0:3], v[176:179], v[128:131], v[0:3]
s_nop 0
s_add_u32 m0, s44, s47
v_mfma_f32_16x16x32_bf16 v[4:7], v[176:179], v[132:135], v[4:7]
s_add_u32 s44, s44, s45
v_exp_f32 v224, v112
v_mfma_f32_16x16x32_bf16 v[12:15], v[180:183], v[132:135], v[12:15]
s_add_u32 s51, s51, 1
v_exp_f32 v225, v113
v_mfma_f32_16x16x32_bf16 v[8:11], v[180:183], v[128:131], v[8:11]
v_exp_f32_e64 v226, v114
v_mfma_f32_16x16x32_bf16 v[16:19], v[184:187], v[128:131], v[16:19]
v_exp_f32_e64 v227, v115
v_mfma_f32_16x16x32_bf16 v[20:23], v[184:187], v[132:135], v[20:23]
v_exp_f32_e64 v228, v116
v_mfma_f32_16x16x32_bf16 v[28:31], v[188:191], v[132:135], v[28:31]
s_cmp_ge_u32 s51, s53
v_exp_f32_e64 v229, v117
s_cbranch_scc0 L_n0
L_sp0:
s_waitcnt vmcnt(12) lgkmcnt(0)
s_cmp_ge_u32 s51, s1
s_cbranch_scc0 L_ev0
s_cmp_eq_u32 s51, s52
s_cbranch_scc1 L_exit0
s_add_u32 s4, s51, 4
s_barrier
s_cmp_gt_u32 s4, s52
s_cbranch_scc1 L_bw0
s_cmp_lg_u32 s4, s52
s_cbranch_scc1 L_bk0
s_getpc_b64 s[4:5]
L_pc0:
s_add_u32 s4, s4, L_exit0-L_pc0
s_addc_u32 s5, s5, 0
v_lshlrev_b32 v246, 3, v238
s_lshl_b32 s6, s40, 13
v_add_u32 v246, s6, v246
s_mov_b32 s6, L_codeend-L_exit0
v_cmp_gt_u32_e64 vcc, s6, v246
s_and_saveexec_b64 s[6:7], vcc
s_cbranch_execz L_tv0
global_load_dword v255, v246, s[4:5]
L_tv0:
s_mov_b64 exec, -1
s_branch L_bk0
L_ev0:
s_barrier
s_bitset0_b64 s[58:59], s51
s_ff1_i32_b64 s53, s[58:59]
s_mov_b32 s62, 0
s_bitcmp1_b64 s[56:57], s51
s_cbranch_scc0 L_rec
s_sub_u32 s0, s0, 16896
s_add_u32 s55, s55, 16896
L_bw0:
v_mfma_f32_16x16x32_bf16 v[24:27], v[188:191], v[128:131], v[24:27]
ds_read_b128 v[144:147], v239 offset:0
ds_read_b128 v[148:151], v239 offset:512
v_mfma_f32_16x16x32_bf16 v[216:219], v[232:235], v[128:131], v[216:219]
buffer_load_dwordx4 v236, s[24:27], s60 offen offset:0  lds
ds_read_b128 v[152:155], v239 offset:64
v_mfma_f32_16x16x32_bf16 v[32:35], v[192:195], v[128:131], v[32:35]
ds_read_b128 v[156:159], v239 offset:576
buffer_load_dwordx4 v237, s[24:27], s60 offen offset:1056  lds
v_mfma_f32_16x16x32_bf16 v[36:39], v[192:195], v[132:135], v[36:39]
ds_read_b128 v[160:163], v239 offset:128
ds_read_b128 v[164:167], v239 offset:640
v_mfma_f32_16x16x32_bf16 v[44:47], v[196:199], v[132:135], v[44:47]
buffer_load_dwordx4 v241, s[24:27], s60 offen offset:2112  lds
ds_read_b128 v[168:171], v239 offset:192
v_mfma_f32_16x16x32_bf16 v[40:43], v[196:199], v[128:131], v[40:43]
ds_read_b128 v[172:175], v239 offset:704
buffer_load_dwordx4 v252, s[24:27], s60 offen offset:3168  lds
v_mfma_f32_16x16x32_bf16 v[48:51], v[200:203], v[128:131], v[48:51]
ds_read_b64_tr_b16 v[176:177], v240 offset:0
v_cvt_pk_bf16_f32 v136, v224, v225
v_mfma_f32_16x16x32_bf16 v[52:55], v[200:203], v[132:135], v[52:55]
s_cmp_eq_u32 s44, s0
v_exp_f32 v230, v118
v_mfma_f32_16x16x32_bf16 v[60:63], v[204:207], v[132:135], v[60:63]
s_cselect_b32 s45, s55, 16896
v_exp_f32_e64 v231, v119
v_mfma_f32_16x16x32_bf16 v[56:59], v[204:207], v[128:131], v[56:59]
ds_read_b64_tr_b16 v[178:179], v240 offset:512
v_cvt_pk_bf16_f32 v137, v226, v227
v_mfma_f32_16x16x32_bf16 v[220:223], v[232:235], v[132:135], v[220:223]
s_waitcnt lgkmcnt(2)
v_exp_f32 v224, v120
v_mfma_f32_16x16x32_bf16 v[96:99], v[144:147], v[64:67], v[208:211]
ds_read_b64_tr_b16 v[180:181], v240 offset:32
v_cvt_pk_bf16_f32 v140, v228, v229
v_mfma_f32_16x16x32_bf16 v[100:103], v[144:147], v[68:71], v[212:215]
ds_read_b64_tr_b16 v[182:183], v240 offset:544
v_exp_f32_e64 v225, v121
v_mfma_f32_16x16x32_bf16 v[108:111], v[148:151], v[68:71], v[212:215]
ds_read_b64_tr_b16 v[184:185], v240 offset:64
v_cvt_pk_bf16_f32 v141, v230, v231
v_mfma_f32_16x16x32_bf16 v[104:107], v[148:151], v[64:67], v[208:211]
s_add_u32 s60, s60, 16384
v_exp_f32_e64 v226, v122
v_mfma_f32_16x16x32_bf16 v[96:99], v[152:155], v[72:75], v[96:99]
ds_read_b64_tr_b16 v[186:187], v240 offset:576
v_or3_b32 v253, v136, v137, v140
v_mfma_f32_16x16x32_bf16 v[100:103], v[152:155], v[76:79], v[100:103]
ds_read_b64_tr_b16 v[188:189], v240 offset:96
v_cvt_pk_bf16_f32 v138, v224, v225
v_add_u32_e64 v239, s45, v239
v_mfma_f32_16x16x32_bf16 v[108:111], v[156:159], v[76:79], v[108:111]
ds_read_b64_tr_b16 v[190:191], v240 offset:608
v_exp_f32_e64 v227, v123
v_mfma_f32_16x16x32_bf16 v[104:107], v[156:159], v[72:75], v[104:107]
v_exp_f32_e64 v228, v124
v_mfma_f32_16x16x32_bf16 v[96:99], v[160:163], v[80:83], v[96:99]
ds_read_b64_tr_b16 v[192:193], v240 offset:128
v_cvt_pk_bf16_f32 v139, v226, v227
v_or3_b32 v253, v253, v141, v138
v_mfma_f32_16x16x32_bf16 v[100:103], v[160:163], v[84:87], v[100:103]
ds_read_b64_tr_b16 v[194:195], v240 offset:640
v_exp_f32_e64 v229, v125
v_mfma_f32_16x16x32_bf16 v[108:111], v[164:167], v[84:87], v[108:111]
ds_read_b64_tr_b16 v[196:197], v240 offset:160
v_exp_f32_e64 v230, v126
v_mfma_f32_16x16x32_bf16 v[104:107], v[164:167], v[80:83], v[104:107]
ds_read_b64_tr_b16 v[198:199], v240 offset:672
v_cvt_pk_bf16_f32 v142, v228, v229
v_mfma_f32_16x16x32_bf16 v[96:99], v[168:171], v[88:91], v[96:99]
ds_read_b64_tr_b16 v[200:201], v240 offset:192
v_exp_f32_e64 v231, v127
v_mfma_f32_16x16x32_bf16 v[100:103], v[168:171], v[92:95], v[100:103]
ds_read_b64_tr_b16 v[202:203], v240 offset:704
v_or3_b32 v253, v253, v139, v142
v_cvt_pk_bf16_f32 v143, v230, v231
v_mfma_f32_16x16x32_bf16 v[108:111], v[172:175], v[92:95], v[108:111]
ds_read_b64_tr_b16 v[204:205], v240 offset:224
v_bitop3_b32 v253, v253, v143, s63 bitop3:0xa8
v_mfma_f32_16x16x32_bf16 v[104:107], v[172:175], v[88:91], v[104:107]
ds_read_b64_tr_b16 v[206:207], v240 offset:736
v_cmp_ne_u32 vcc, 0, v253
v_add_u32_e64 v240, s45, v240
s_branch L_be0
L_sp1:
s_waitcnt vmcnt(12) lgkmcnt(0)
s_cmp_ge_u32 s51, s1
s_cbranch_scc0 L_ev1
s_cmp_eq_u32 s51, s52
s_cbranch_scc1 L_exit1
s_add_u32 s4, s51, 4
s_barrier
s_cmp_gt_u32 s4, s52
s_cbranch_scc1 L_bw1
s_cmp_lg_u32 s4, s52
s_cbranch_scc1 L_bk1
s_getpc_b64 s[4:5]
L_pc1:
s_add_u32 s4, s4, L_exit0-L_pc1
s_addc_u32 s5, s5, 0
v_lshlrev_b32 v246, 3, v238
s_lshl_b32 s6, s40, 13
v_add_u32 v246, s6, v246
s_mov_b32 s6, L_codeend-L_exit0
v_cmp_gt_u32_e64 vcc, s6, v246
s_and_saveexec_b64 s[6:7], vcc
s_cbranch_execz L_tv1
global_load_dword v255, v246, s[4:5]
L_tv1:
s_mov_b64 exec, -1
s_branch L_bk1
L_ev1:
s_barrier
s_bitset0_b64 s[58:59], s51
s_ff1_i32_b64 s53, s[58:59]
s_mov_b32 s62, 1
s_bitcmp1_b64 s[56:57], s51
s_cbranch_scc0 L_rec
s_sub_u32 s0, s0, 16896
s_add_u32 s55, s55, 16896
L_bw1:
v_mfma_f32_16x16x32_bf16 v[24:27], v[188:191], v[136:139], v[24:27]
ds_read_b128 v[144:147], v239 offset:0
ds_read_b128 v[148:151], v239 offset:512
v_mfma_f32_16x16x32_bf16 v[216:219], v[232:235], v[136:139], v[216:219]
buffer_load_dwordx4 v236, s[24:27], s60 offen offset:0  lds
ds_read_b128 v[152:155], v239 offset:64
v_mfma_f32_16x16x32_bf16 v[32:35], v[192:195], v[136:139], v[32:35]
ds_read_b128 v[156:159], v239 offset:576
buffer_load_dwordx4 v237, s[24:27], s60 offen offset:1056  lds
v_mfma_f32_16x16x32_bf16 v[36:39], v[192:195], v[140:143], v[36:39]
ds_read_b128 v[160:163], v239 offset:128
ds_read_b128 v[164:167], v239 offset:640
v_mfma_f32_16x16x32_bf16 v[44:47], v[196:199], v[140:143], v[44:47]
buffer_load_dwordx4 v241, s[24:27], s60 offen offset:2112  lds
ds_read_b128 v[168:171], v239 offset:192
v_mfma_f32_16x16x32_bf16 v[40:43], v[196:199], v[136:139], v[40:43]
ds_read_b128 v[172:175], v239 offset:704
buffer_load_dwordx4 v252, s[24:27], s60 offen offset:3168  lds
v_mfma_f32_16x16x32_bf16 v[48:51], v[200:203], v[136:139], v[48:51]
ds_read_b64_tr_b16 v[176:177], v240 offset:0
v_cvt_pk_bf16_f32 v128, v224, v225
v_mfma_f32_16x16x32_bf16 v[52:55], v[200:203], v[140:143], v[52:55]
s_cmp_eq_u32 s44, s0
v_exp_f32 v230, v102
v_mfma_f32_16x16x32_bf16 v[60:63], v[204:207], v[140:143], v[60:63]
s_cselect_b32 s45, s55, 16896
v_exp_f32_e64 v231, v103
v_mfma_f32_16x16x32_bf16 v[56:59], v[204:207], v[136:139], v[56:59]
ds_read_b64_tr_b16 v[178:179], v240 offset:512
v_cvt_pk_bf16_f32 v129, v226, v227
v_mfma_f32_16x16x32_bf16 v[220:223], v[232:235], v[140:143], v[220:223]
s_waitcnt lgkmcnt(2)
v_exp_f32 v224, v104
v_mfma_f32_16x16x32_bf16 v[112:115], v[144:147], v[64:67], v[208:211]
ds_read_b64_tr_b16 v[180:181], v240 offset:32
v_cvt_pk_bf16_f32 v132, v228, v229
v_mfma_f32_16x16x32_bf16 v[116:119], v[144:147], v[68:71], v[212:215]
ds_read_b64_tr_b16 v[182:183], v240 offset:544
v_exp_f32_e64 v225, v105
v_mfma_f32_16x16x32_bf16 v[124:127], v[148:151], v[68:71], v[212:215]
ds_read_b64_tr_b16 v[184:185], v240 offset:64
v_cvt_pk_bf16_f32 v133, v230, v231
v_mfma_f32_16x16x32_bf16 v[120:123], v[148:151], v[64:67], v[208:211]
s_add_u32 s60, s60, 16384
v_exp_f32_e64 v226, v106
v_mfma_f32_16x16x32_bf16 v[112:115], v[152:155], v[72:75], v[112:115]
ds_read_b64_tr_b16 v[186:187], v240 offset:576
v_or3_b32 v253, v128, v129, v132
v_mfma_f32_16x16x32_bf16 v[116:119], v[152:155], v[76:79], v[116:119]
ds_read_b64_tr_b16 v[188:189], v240 offset:96
v_cvt_pk_bf16_f32 v130, v224, v225
v_add_u32_e64 v239, s45, v239
v_mfma_f32_16x16x32_bf16 v[124:127], v[156:159], v[76:79], v[124:127]
ds_read_b64_tr_b16 v[190:191], v240 offset:608
v_exp_f32_e64 v227, v107
v_mfma_f32_16x16x32_bf16 v[120:123], v[156:159], v[72:75], v[120:123]
v_exp_f32_e64 v228, v108
v_mfma_f32_16x16x32_bf16 v[112:115], v[160:163], v[80:83], v[112:115]
ds_read_b64_tr_b16 v[192:193], v240 offset:128
v_cvt_pk_bf16_f32 v131, v226, v227
v_or3_b32 v253, v253, v133, v130
v_mfma_f32_16x16x32_bf16 v[116:119], v[160:163], v[84:87], v[116:119]
ds_read_b64_tr_b16 v[194:195], v240 offset:640
v_exp_f32_e64 v229, v109
v_mfma_f32_16x16x32_bf16 v[124:127], v[164:167], v[84:87], v[124:127]
ds_read_b64_tr_b16 v[196:197], v240 offset:160
v_exp_f32_e64 v230, v110
v_mfma_f32_16x16x32_bf16 v[120:123], v[164:167], v[80:83], v[120:123]
ds_read_b64_tr_b16 v[198:199], v240 offset:672
v_cvt_pk_bf16_f32 v134, v228, v229
v_mfma_f32_16x16x32_bf16 v[112:115], v[168:171], v[88:91], v[112:115]
ds_read_b64_tr_b16 v[200:201], v240 offset:192
v_exp_f32_e64 v231, v111
v_mfma_f32_16x16x32_bf16 v[116:119], v[168:171], v[92:95], v[116:119]
ds_read_b64_tr_b16 v[202:203], v240 offset:704
v_or3_b32 v253, v253, v131, v134
v_cvt_pk_bf16_f32 v135, v230, v231
v_mfma_f32_16x16x32_bf16 v[124:127], v[172:175], v[92:95], v[124:127]
ds_read_b64_tr_b16 v[204:205], v240 offset:224
v_bitop3_b32 v253, v253, v135, s63 bitop3:0xa8
v_mfma_f32_16x16x32_bf16 v[120:123], v[172:175], v[88:91], v[120:123]
ds_read_b64_tr_b16 v[206:207], v240 offset:736
v_cmp_ne_u32 vcc, 0, v253
v_add_u32 v240, s45, v240
s_branch L_be1
L_rec:
s_mov_b32 s4, m0
s_cmp_ge_u32 s61, 6
s_cbranch_scc1 L_wt6_12
s_cmp_ge_u32 s61, 3
s_cbranch_scc1 L_wt3_6
s_cmp_ge_u32 s61, 1
s_cbranch_scc1 L_wt1_3
ds_read_b64_tr_b16 a[0:1], v254 offset:50688
ds_read_b64_tr_b16 a[4:5], v254 offset:50696
ds_read_b64_tr_b16 a[8:9], v254 offset:50752
ds_read_b64_tr_b16 a[12:13], v254 offset:50760
ds_read_b64_tr_b16 a[16:17], v254 offset:50816
ds_read_b64_tr_b16 a[20:21], v254 offset:50824
ds_read_b64_tr_b16 a[24:25], v254 offset:50880
ds_read_b64_tr_b16 a[28:29], v254 offset:50888
s_branch L_rec_e
L_wt1_3:
s_cmp_ge_u32 s61, 2
s_cbranch_scc1 L_wt2_3
s_add_u32 m0, s47, 135168
s_nop 0
buffer_load_dwordx4 v236, s[24:27], s60 offen offset:0  lds
buffer_load_dwordx4 v237, s[24:27], s60 offen offset:1056  lds
buffer_load_dwordx4 v241, s[24:27], s60 offen offset:2112  lds
buffer_load_dwordx4 v252, s[24:27], s60 offen offset:3168  lds
s_add_u32 s60, s60, 16384
s_branch L_rec_e
L_wt2_3:
s_nop 0
ds_read_b64_tr_b16 a[2:3], v254 offset:50688
ds_read_b64_tr_b16 a[6:7], v254 offset:50696
ds_read_b64_tr_b16 a[10:11], v254 offset:50752
ds_read_b64_tr_b16 a[14:15], v254 offset:50760
ds_read_b64_tr_b16 a[18:19], v254 offset:50816
ds_read_b64_tr_b16 a[22:23], v254 offset:50824
ds_read_b64_tr_b16 a[26:27], v254 offset:50880
ds_read_b64_tr_b16 a[30:31], v254 offset:50888
s_branch L_rec_e
L_wt3_6:
s_cmp_ge_u32 s61, 4
s_cbranch_scc1 L_wt4_6
s_nop 0
ds_read_b64_tr_b16 a[32:33], v254 offset:33792
ds_read_b64_tr_b16 a[36:37], v254 offset:33800
ds_read_b64_tr_b16 a[40:41], v254 offset:33856
ds_read_b64_tr_b16 a[44:45], v254 offset:33864
ds_read_b64_tr_b16 a[48:49], v254 offset:33920
ds_read_b64_tr_b16 a[52:53], v254 offset:33928
ds_read_b64_tr_b16 a[56:57], v254 offset:33984
ds_read_b64_tr_b16 a[60:61], v254 offset:33992
s_add_u32 m0, s47, 135168
s_nop 0
s_nop 0
buffer_load_dwordx4 v236, s[24:27], s60 offen offset:0  lds
buffer_load_dwordx4 v237, s[24:27], s60 offen offset:1056  lds
buffer_load_dwordx4 v241, s[24:27], s60 offen offset:2112  lds
buffer_load_dwordx4 v252, s[24:27], s60 offen offset:3168  lds
s_add_u32 s60, s60, 16384
s_branch L_rec_e
L_wt4_6:
s_cmp_ge_u32 s61, 5
s_cbranch_scc1 L_wt5_6
s_add_u32 m0, s47, 118272
s_nop 0
buffer_load_dwordx4 v236, s[24:27], s60 offen offset:0  lds
buffer_load_dwordx4 v237, s[24:27], s60 offen offset:1056  lds
buffer_load_dwordx4 v241, s[24:27], s60 offen offset:2112  lds
buffer_load_dwordx4 v252, s[24:27], s60 offen offset:3168  lds
s_add_u32 s60, s60, 16384
s_branch L_rec_e
L_wt5_6:
s_nop 0
ds_read_b64_tr_b16 a[34:35], v254 offset:50688
ds_read_b64_tr_b16 a[38:39], v254 offset:50696
ds_read_b64_tr_b16 a[42:43], v254 offset:50752
ds_read_b64_tr_b16 a[46:47], v254 offset:50760
ds_read_b64_tr_b16 a[50:51], v254 offset:50816
ds_read_b64_tr_b16 a[54:55], v254 offset:50824
ds_read_b64_tr_b16 a[58:59], v254 offset:50880
ds_read_b64_tr_b16 a[62:63], v254 offset:50888
s_branch L_rec_e
L_wt6_12:
s_cmp_ge_u32 s61, 9
s_cbranch_scc1 L_wt9_12
s_cmp_ge_u32 s61, 7
s_cbranch_scc1 L_wt7_9
s_nop 0
ds_read_b64_tr_b16 a[64:65], v254 offset:16896
ds_read_b64_tr_b16 a[68:69], v254 offset:16904
ds_read_b64_tr_b16 a[72:73], v254 offset:16960
ds_read_b64_tr_b16 a[76:77], v254 offset:16968
ds_read_b64_tr_b16 a[80:81], v254 offset:17024
ds_read_b64_tr_b16 a[84:85], v254 offset:17032
ds_read_b64_tr_b16 a[88:89], v254 offset:17088
ds_read_b64_tr_b16 a[92:93], v254 offset:17096
s_add_u32 m0, s47, 135168
s_nop 0
s_nop 0
buffer_load_dwordx4 v236, s[24:27], s60 offen offset:0  lds
buffer_load_dwordx4 v237, s[24:27], s60 offen offset:1056  lds
buffer_load_dwordx4 v241, s[24:27], s60 offen offset:2112  lds
buffer_load_dwordx4 v252, s[24:27], s60 offen offset:3168  lds
s_add_u32 s60, s60, 16384
s_branch L_rec_e
L_wt7_9:
s_cmp_ge_u32 s61, 8
s_cbranch_scc1 L_wt8_9
s_nop 0
ds_read_b64_tr_b16 a[66:67], v254 offset:33792
ds_read_b64_tr_b16 a[70:71], v254 offset:33800
ds_read_b64_tr_b16 a[74:75], v254 offset:33856
ds_read_b64_tr_b16 a[78:79], v254 offset:33864
ds_read_b64_tr_b16 a[82:83], v254 offset:33920
ds_read_b64_tr_b16 a[86:87], v254 offset:33928
ds_read_b64_tr_b16 a[90:91], v254 offset:33984
ds_read_b64_tr_b16 a[94:95], v254 offset:33992
s_add_u32 m0, s47, 101376
s_nop 0
s_nop 0
buffer_load_dwordx4 v236, s[24:27], s60 offen offset:0  lds
buffer_load_dwordx4 v237, s[24:27], s60 offen offset:1056  lds
buffer_load_dwordx4 v241, s[24:27], s60 offen offset:2112  lds
buffer_load_dwordx4 v252, s[24:27], s60 offen offset:3168  lds
s_add_u32 s60, s60, 16384
s_branch L_rec_e
L_wt8_9:
s_nop 0
ds_read_b64_tr_b16 a[96:97], v254 offset:0
ds_read_b64_tr_b16 a[100:101], v254 offset:8
ds_read_b64_tr_b16 a[104:105], v254 offset:64
ds_read_b64_tr_b16 a[108:109], v254 offset:72
ds_read_b64_tr_b16 a[112:113], v254 offset:128
ds_read_b64_tr_b16 a[116:117], v254 offset:136
ds_read_b64_tr_b16 a[120:121], v254 offset:192
ds_read_b64_tr_b16 a[124:125], v254 offset:200
s_add_u32 m0, s47, 118272
s_nop 0
s_nop 0
buffer_load_dwordx4 v236, s[24:27], s60 offen offset:0  lds
buffer_load_dwordx4 v237, s[24:27], s60 offen offset:1056  lds
buffer_load_dwordx4 v241, s[24:27], s60 offen offset:2112  lds
buffer_load_dwordx4 v252, s[24:27], s60 offen offset:3168  lds
s_add_u32 s60, s60, 16384
s_branch L_rec_e
L_wt9_12:
s_cmp_ge_u32 s61, 10
s_cbranch_scc1 L_wt10_12
s_nop 0
ds_read_b64_tr_b16 a[98:99], v254 offset:50688
ds_read_b64_tr_b16 a[102:103], v254 offset:50696
ds_read_b64_tr_b16 a[106:107], v254 offset:50752
ds_read_b64_tr_b16 a[110:111], v254 offset:50760
ds_read_b64_tr_b16 a[114:115], v254 offset:50816
ds_read_b64_tr_b16 a[118:119], v254 offset:50824
ds_read_b64_tr_b16 a[122:123], v254 offset:50880
ds_read_b64_tr_b16 a[126:127], v254 offset:50888
s_add_u32 m0, s47, 84480
s_nop 0
s_nop 0
buffer_load_dwordx4 v236, s[24:27], s60 offen offset:0  lds
buffer_load_dwordx4 v237, s[24:27], s60 offen offset:1056  lds
buffer_load_dwordx4 v241, s[24:27], s60 offen offset:2112  lds
buffer_load_dwordx4 v252, s[24:27], s60 offen offset:3168  lds
s_add_u32 s60, s60, 16384
s_branch L_rec_e
L_wt10_12:
s_cmp_ge_u32 s61, 11
s_cbranch_scc1 L_wt11_12
s_nop 0
ds_read_b64_tr_b16 a[128:129], v254 offset:16896
ds_read_b64_tr_b16 a[132:133], v254 offset:16904
ds_read_b64_tr_b16 a[136:137], v254 offset:16960
ds_read_b64_tr_b16 a[140:141], v254 offset:16968
ds_read_b64_tr_b16 a[144:145], v254 offset:17024
ds_read_b64_tr_b16 a[148:149], v254 offset:17032
ds_read_b64_tr_b16 a[152:153], v254 offset:17088
ds_read_b64_tr_b16 a[156:157], v254 offset:17096
s_add_u32 m0, s47, 135168
s_nop 0
s_nop 0
buffer_load_dwordx4 v236, s[24:27], s60 offen offset:0  lds
buffer_load_dwordx4 v237, s[24:27], s60 offen offset:1056  lds
buffer_load_dwordx4 v241, s[24:27], s60 offen offset:2112  lds
buffer_load_dwordx4 v252, s[24:27], s60 offen offset:3168  lds
s_add_u32 s60, s60, 16384
s_branch L_rec_e
L_wt11_12:
s_add_u32 m0, s47, 101376
s_nop 0
buffer_load_dwordx4 v236, s[24:27], s60 offen offset:0  lds
buffer_load_dwordx4 v237, s[24:27], s60 offen offset:1056  lds
buffer_load_dwordx4 v241, s[24:27], s60 offen offset:2112  lds
buffer_load_dwordx4 v252, s[24:27], s60 offen offset:3168  lds
s_add_u32 s60, s60, 16384
L_rec_e:
s_mov_b32 m0, s4
s_add_u32 s61, s61, 1
s_cmp_eq_u32 s62, 0
s_cbranch_scc1 L_bk0
s_branch L_bk1
L_rare0:
v_max3_f32 v246, v112, v113, v114
v_max3_f32 v246, v246, v115, v120
v_max3_f32 v246, v246, v121, v122
v_max_f32 v246, v246, v123
v_mov_b32 v248, v246
s_nop 1
v_permlane32_swap_b32 v246, v248
v_max_f32 v246, v246, v248
v_mov_b32 v248, v246
s_nop 1
v_permlane16_swap_b32 v246, v248
v_max_f32 v246, v246, v248
v_add_f32 v246, 0x41200000, v246
v_max3_f32 v247, v116, v117, v118
v_max3_f32 v247, v247, v119, v124
v_max3_f32 v247, v247, v125, v126
v_max_f32 v247, v247, v127
v_mov_b32 v248, v247
s_nop 1
v_permlane32_swap_b32 v247, v248
v_max_f32 v247, v247, v248
v_mov_b32 v248, v247
s_nop 1
v_permlane16_swap_b32 v247, v248
v_max_f32_e64 v247, v247, v248
v_add_f32 v247, 0x41200000, v247
v_max_f32 v246, 0, v246
v_max_f32 v247, 0, v247
v_exp_f32 v248, -v246
v_exp_f32 v249, -v247
v_sub_f32 v144, v112, v246
v_exp_f32 v144, v144
v_sub_f32 v145, v113, v246
v_exp_f32 v145, v145
v_sub_f32 v146, v114, v246
v_exp_f32 v146, v146
v_sub_f32 v147, v115, v246
v_exp_f32 v147, v147
v_sub_f32 v148, v116, v247
v_exp_f32 v148, v148
v_sub_f32 v149, v117, v247
v_exp_f32 v149, v149
v_sub_f32 v150, v118, v247
v_exp_f32 v150, v150
v_sub_f32 v151, v119, v247
v_exp_f32 v151, v151
v_sub_f32 v152, v120, v246
v_exp_f32 v152, v152
v_sub_f32 v153, v121, v246
v_exp_f32 v153, v153
v_sub_f32 v154, v122, v246
v_exp_f32 v154, v154
v_sub_f32 v155, v123, v246
v_exp_f32 v155, v155
v_sub_f32 v156, v124, v247
v_exp_f32 v156, v156
v_sub_f32 v157, v125, v247
v_exp_f32 v157, v157
v_sub_f32 v158, v126, v247
v_exp_f32 v158, v158
v_sub_f32 v159, v127, v247
v_exp_f32 v159, v159
v_sub_f32 v208, v208, v246
v_sub_f32 v209, v209, v246
v_sub_f32 v210, v210, v246
v_sub_f32 v211, v211, v246
v_sub_f32 v212, v212, v247
v_sub_f32 v213, v213, v247
v_sub_f32 v214, v214, v247
v_sub_f32 v215, v215, v247
v_cvt_pk_bf16_f32 v136, v144, v145
v_cvt_pk_bf16_f32 v137, v146, v147
v_cvt_pk_bf16_f32 v140, v148, v149
v_cvt_pk_bf16_f32 v141, v150, v151
v_cvt_pk_bf16_f32 v138, v152, v153
v_cvt_pk_bf16_f32 v139, v154, v155
v_cvt_pk_bf16_f32 v142, v156, v157
v_cvt_pk_bf16_f32 v143, v158, v159
v_sub_f32 v96, v96, v246
v_sub_f32 v97, v97, v246
v_sub_f32 v98, v98, v246
v_sub_f32 v99, v99, v246
v_sub_f32 v100, v100, v247
v_sub_f32 v101, v101, v247
v_sub_f32 v102, v102, v247
v_sub_f32 v103, v103, v247
v_sub_f32 v104, v104, v246
v_sub_f32 v105, v105, v246
v_sub_f32 v106, v106, v246
v_sub_f32 v107, v107, v246
v_sub_f32 v108, v108, v247
v_sub_f32 v109, v109, v247
v_sub_f32 v110, v110, v247
v_sub_f32 v111, v111, v247
v_mul_f32 v216, v248, v216
v_mul_f32 v217, v248, v217
v_mul_f32 v218, v248, v218
v_mul_f32 v219, v248, v219
v_mul_f32 v220, v249, v220
v_mul_f32 v221, v249, v221
v_mul_f32 v222, v249, v222
v_mul_f32 v223, v249, v223
v_mul_f32 v0, v248, v0
v_mul_f32 v1, v248, v1
v_mul_f32 v2, v248, v2
v_mul_f32 v3, v248, v3
v_mul_f32 v4, v249, v4
v_mul_f32 v5, v249, v5
v_mul_f32 v6, v249, v6
v_mul_f32 v7, v249, v7
v_mul_f32 v8, v248, v8
v_mul_f32 v9, v248, v9
v_mul_f32 v10, v248, v10
v_mul_f32 v11, v248, v11
v_mul_f32 v12, v249, v12
v_mul_f32 v13, v249, v13
v_mul_f32 v14, v249, v14
v_mul_f32 v15, v249, v15
v_mul_f32 v16, v248, v16
v_mul_f32 v17, v248, v17
v_mul_f32 v18, v248, v18
v_mul_f32 v19, v248, v19
v_mul_f32 v20, v249, v20
v_mul_f32 v21, v249, v21
v_mul_f32 v22, v249, v22
v_mul_f32 v23, v249, v23
v_mul_f32 v24, v248, v24
v_mul_f32 v25, v248, v25
v_mul_f32 v26, v248, v26
v_mul_f32 v27, v248, v27
v_mul_f32 v28, v249, v28
v_mul_f32 v29, v249, v29
v_mul_f32 v30, v249, v30
v_mul_f32 v31, v249, v31
v_mul_f32 v32, v248, v32
v_mul_f32 v33, v248, v33
v_mul_f32 v34, v248, v34
v_mul_f32 v35, v248, v35
v_mul_f32 v36, v249, v36
v_mul_f32 v37, v249, v37
v_mul_f32 v38, v249, v38
v_mul_f32 v39, v249, v39
v_mul_f32 v40, v248, v40
v_mul_f32 v41, v248, v41
v_mul_f32 v42, v248, v42
v_mul_f32 v43, v248, v43
v_mul_f32 v44, v249, v44
v_mul_f32 v45, v249, v45
v_mul_f32 v46, v249, v46
v_mul_f32 v47, v249, v47
v_mul_f32 v48, v248, v48
v_mul_f32 v49, v248, v49
v_mul_f32 v50, v248, v50
v_mul_f32 v51, v248, v51
v_mul_f32 v52, v249, v52
v_mul_f32 v53, v249, v53
v_mul_f32 v54, v249, v54
v_mul_f32 v55, v249, v55
v_mul_f32 v56, v248, v56
v_mul_f32 v57, v248, v57
v_mul_f32 v58, v248, v58
v_mul_f32 v59, v248, v59
v_mul_f32 v60, v249, v60
v_mul_f32 v61, v249, v61
v_mul_f32 v62, v249, v62
v_mul_f32_e64 v63, v249, v63
s_cmp_eq_u32 s62, 2
s_cbranch_scc1 L_eb0
s_branch L_top1
L_rare1:
v_max3_f32 v246, v96, v97, v98
v_max3_f32 v246, v246, v99, v104
v_max3_f32 v246, v246, v105, v106
v_max_f32 v246, v246, v107
v_mov_b32 v248, v246
s_nop 1
v_permlane32_swap_b32 v246, v248
v_max_f32 v246, v246, v248
v_mov_b32 v248, v246
s_nop 1
v_permlane16_swap_b32 v246, v248
v_max_f32_e64 v246, v246, v248
v_add_f32 v246, 0x41200000, v246
v_max3_f32 v247, v100, v101, v102
v_max3_f32 v247, v247, v103, v108
v_max3_f32 v247, v247, v109, v110
v_max_f32 v247, v247, v111
v_mov_b32 v248, v247
s_nop 1
v_permlane32_swap_b32 v247, v248
v_max_f32 v247, v247, v248
v_mov_b32 v248, v247
s_nop 1
v_permlane16_swap_b32 v247, v248
v_max_f32_e64 v247, v247, v248
v_add_f32 v247, 0x41200000, v247
v_max_f32 v246, 0, v246
v_max_f32 v247, 0, v247
v_exp_f32 v248, -v246
v_exp_f32 v249, -v247
v_sub_f32 v144, v96, v246
v_exp_f32 v144, v144
v_sub_f32 v145, v97, v246
v_exp_f32 v145, v145
v_sub_f32 v146, v98, v246
v_exp_f32 v146, v146
v_sub_f32 v147, v99, v246
v_exp_f32 v147, v147
v_sub_f32 v148, v100, v247
v_exp_f32 v148, v148
v_sub_f32 v149, v101, v247
v_exp_f32 v149, v149
v_sub_f32 v150, v102, v247
v_exp_f32 v150, v150
v_sub_f32 v151, v103, v247
v_exp_f32 v151, v151
v_sub_f32 v152, v104, v246
v_exp_f32 v152, v152
v_sub_f32 v153, v105, v246
v_exp_f32 v153, v153
v_sub_f32 v154, v106, v246
v_exp_f32 v154, v154
v_sub_f32 v155, v107, v246
v_exp_f32 v155, v155
v_sub_f32 v156, v108, v247
v_exp_f32 v156, v156
v_sub_f32 v157, v109, v247
v_exp_f32 v157, v157
v_sub_f32 v158, v110, v247
v_exp_f32 v158, v158
v_sub_f32 v159, v111, v247
v_exp_f32 v159, v159
v_sub_f32 v208, v208, v246
v_sub_f32 v209, v209, v246
v_sub_f32 v210, v210, v246
v_sub_f32 v211, v211, v246
v_sub_f32 v212, v212, v247
v_sub_f32 v213, v213, v247
v_sub_f32 v214, v214, v247
v_sub_f32 v215, v215, v247
v_cvt_pk_bf16_f32 v128, v144, v145
v_cvt_pk_bf16_f32 v129, v146, v147
v_cvt_pk_bf16_f32 v132, v148, v149
v_cvt_pk_bf16_f32 v133, v150, v151
v_cvt_pk_bf16_f32 v130, v152, v153
v_cvt_pk_bf16_f32 v131, v154, v155
v_cvt_pk_bf16_f32 v134, v156, v157
v_cvt_pk_bf16_f32 v135, v158, v159
v_sub_f32 v112, v112, v246
v_sub_f32 v113, v113, v246
v_sub_f32 v114, v114, v246
v_sub_f32 v115, v115, v246
v_sub_f32 v116, v116, v247
v_sub_f32 v117, v117, v247
v_sub_f32 v118, v118, v247
v_sub_f32 v119, v119, v247
v_sub_f32 v120, v120, v246
v_sub_f32 v121, v121, v246
v_sub_f32 v122, v122, v246
v_sub_f32 v123, v123, v246
v_sub_f32 v124, v124, v247
v_sub_f32 v125, v125, v247
v_sub_f32 v126, v126, v247
v_sub_f32 v127, v127, v247
v_mul_f32 v216, v248, v216
v_mul_f32 v217, v248, v217
v_mul_f32 v218, v248, v218
v_mul_f32 v219, v248, v219
v_mul_f32 v220, v249, v220
v_mul_f32 v221, v249, v221
v_mul_f32 v222, v249, v222
v_mul_f32 v223, v249, v223
v_mul_f32 v0, v248, v0
v_mul_f32 v1, v248, v1
v_mul_f32 v2, v248, v2
v_mul_f32 v3, v248, v3
v_mul_f32 v4, v249, v4
v_mul_f32 v5, v249, v5
v_mul_f32 v6, v249, v6
v_mul_f32 v7, v249, v7
v_mul_f32 v8, v248, v8
v_mul_f32 v9, v248, v9
v_mul_f32 v10, v248, v10
v_mul_f32 v11, v248, v11
v_mul_f32 v12, v249, v12
v_mul_f32 v13, v249, v13
v_mul_f32 v14, v249, v14
v_mul_f32 v15, v249, v15
v_mul_f32 v16, v248, v16
v_mul_f32 v17, v248, v17
v_mul_f32 v18, v248, v18
v_mul_f32 v19, v248, v19
v_mul_f32 v20, v249, v20
v_mul_f32 v21, v249, v21
v_mul_f32 v22, v249, v22
v_mul_f32 v23, v249, v23
v_mul_f32 v24, v248, v24
v_mul_f32 v25, v248, v25
v_mul_f32 v26, v248, v26
v_mul_f32 v27, v248, v27
v_mul_f32 v28, v249, v28
v_mul_f32 v29, v249, v29
v_mul_f32 v30, v249, v30
v_mul_f32 v31, v249, v31
v_mul_f32 v32, v248, v32
v_mul_f32 v33, v248, v33
v_mul_f32 v34, v248, v34
v_mul_f32 v35, v248, v35
v_mul_f32 v36, v249, v36
v_mul_f32 v37, v249, v37
v_mul_f32 v38, v249, v38
v_mul_f32 v39, v249, v39
v_mul_f32 v40, v248, v40
v_mul_f32 v41, v248, v41
v_mul_f32 v42, v248, v42
v_mul_f32 v43, v248, v43
v_mul_f32 v44, v249, v44
v_mul_f32 v45, v249, v45
v_mul_f32 v46, v249, v46
v_mul_f32 v47, v249, v47
v_mul_f32 v48, v248, v48
v_mul_f32 v49, v248, v49
v_mul_f32 v50, v248, v50
v_mul_f32 v51, v248, v51
v_mul_f32 v52, v249, v52
v_mul_f32 v53, v249, v53
v_mul_f32 v54, v249, v54
v_mul_f32 v55, v249, v55
v_mul_f32 v56, v248, v56
v_mul_f32 v57, v248, v57
v_mul_f32 v58, v248, v58
v_mul_f32 v59, v248, v59
v_mul_f32 v60, v249, v60
v_mul_f32 v61, v249, v61
v_mul_f32 v62, v249, v62
v_mul_f32_e64 v63, v249, v63
s_cmp_eq_u32 s62, 2
s_cbranch_scc1 L_eb1
s_branch L_top0
L_exit0:
s_barrier
s_mov_b32 s62, 2
v_mfma_f32_16x16x32_bf16 v[24:27], v[188:191], v[128:131], v[24:27]
ds_read_b64_tr_b16 v[176:177], v240 offset:0
ds_read_b64_tr_b16 v[178:179], v240 offset:512
v_mfma_f32_16x16x32_bf16 v[216:219], v[232:235], v[128:131], v[216:219]
ds_read_b64_tr_b16 v[180:181], v240 offset:32
ds_read_b64_tr_b16 v[182:183], v240 offset:544
v_mfma_f32_16x16x32_bf16 v[32:35], v[192:195], v[128:131], v[32:35]
ds_read_b64_tr_b16 v[184:185], v240 offset:64
ds_read_b64_tr_b16 v[186:187], v240 offset:576
v_mfma_f32_16x16x32_bf16 v[36:39], v[192:195], v[132:135], v[36:39]
ds_read_b64_tr_b16 v[188:189], v240 offset:96
ds_read_b64_tr_b16 v[190:191], v240 offset:608
v_mfma_f32_16x16x32_bf16 v[44:47], v[196:199], v[132:135], v[44:47]
ds_read_b64_tr_b16 v[192:193], v240 offset:128
ds_read_b64_tr_b16 v[194:195], v240 offset:640
v_cvt_pk_bf16_f32 v136, v224, v225
v_cvt_pk_bf16_f32 v137, v226, v227
v_exp_f32 v230, v118
v_exp_f32 v231, v119
v_mfma_f32_16x16x32_bf16 v[40:43], v[196:199], v[128:131], v[40:43]
ds_read_b64_tr_b16 v[196:197], v240 offset:160
ds_read_b64_tr_b16 v[198:199], v240 offset:672
v_cvt_pk_bf16_f32 v140, v228, v229
v_exp_f32 v224, v120
v_exp_f32 v225, v121
v_cvt_pk_bf16_f32 v141, v230, v231
v_mfma_f32_16x16x32_bf16 v[48:51], v[200:203], v[128:131], v[48:51]
v_exp_f32 v226, v122
v_exp_f32 v227, v123
v_cvt_pk_bf16_f32 v138, v224, v225
v_mfma_f32_16x16x32_bf16 v[52:55], v[200:203], v[132:135], v[52:55]
ds_read_b64_tr_b16 v[200:201], v240 offset:192
ds_read_b64_tr_b16 v[202:203], v240 offset:704
v_exp_f32 v228, v124
v_exp_f32 v229, v125
v_cvt_pk_bf16_f32 v139, v226, v227
v_mfma_f32_16x16x32_bf16 v[60:63], v[204:207], v[132:135], v[60:63]
v_exp_f32 v230, v126
v_exp_f32 v231, v127
v_cvt_pk_bf16_f32 v142, v228, v229
v_mfma_f32_16x16x32_bf16 v[56:59], v[204:207], v[128:131], v[56:59]
ds_read_b64_tr_b16 v[204:205], v240 offset:224
ds_read_b64_tr_b16 v[206:207], v240 offset:736
v_or3_b32 v253, v136, v137, v140
v_cvt_pk_bf16_f32 v143, v230, v231
v_or3_b32 v253, v253, v141, v138
v_mfma_f32_16x16x32_bf16 v[220:223], v[232:235], v[132:135], v[220:223]
v_or3_b32 v253, v253, v139, v142
v_bitop3_b32 v253, v253, v143, s63 bitop3:0xa8
v_cmp_ne_u32_e64 vcc, 0, v253
s_cbranch_vccnz L_rare0
L_eb0:
s_waitcnt lgkmcnt(8)
v_mfma_f32_16x16x32_bf16 v[216:219], v[232:235], v[136:139], v[216:219]
s_nop 0
s_and_b32 s6, s40, 1
v_mfma_f32_16x16x32_bf16 v[220:223], v[232:235], v[140:143], v[220:223]
s_nop 0
s_lshl_b32 s4, s2, 1
v_mfma_f32_16x16x32_bf16 v[0:3], v[176:179], v[136:139], v[0:3]
s_nop 0
s_add_u32 s6, s4, s6
v_mfma_f32_16x16x32_bf16 v[4:7], v[176:179], v[140:143], v[4:7]
s_nop 0
s_lshl_b32 s4, s6, 13
v_mfma_f32_16x16x32_bf16 v[12:15], v[180:183], v[140:143], v[12:15]
s_add_u32 s4, s4, 25165824
v_mfma_f32_16x16x32_bf16 v[8:11], v[180:183], v[136:139], v[8:11]
s_nop 0
s_lshl_b32 s7, s6, 8
v_mfma_f32_16x16x32_bf16 v[16:19], v[184:187], v[136:139], v[16:19]
s_add_u32 s7, s7, 29360128
v_mfma_f32_16x16x32_bf16 v[20:23], v[184:187], v[140:143], v[20:23]
s_add_u32 s5, s4, 4096
v_mfma_f32_16x16x32_bf16 v[28:31], v[188:191], v[140:143], v[28:31]
s_nop 0
s_lshr_b32 s3, s40, 1
v_mfma_f32_16x16x32_bf16 v[24:27], v[188:191], v[136:139], v[24:27]
s_nop 0
s_waitcnt lgkmcnt(0)
v_mfma_f32_16x16x32_bf16 v[32:35], v[192:195], v[136:139], v[32:35]
s_nop 0
s_cmp_eq_u32 s3, s41
v_mfma_f32_16x16x32_bf16 v[36:39], v[192:195], v[140:143], v[36:39]
v_mov_b32_e64 v224, v208
v_mfma_f32_16x16x32_bf16 v[44:47], v[196:199], v[140:143], v[44:47]
v_mov_b32_e64 v225, v212
v_mfma_f32_16x16x32_bf16 v[40:43], v[196:199], v[136:139], v[40:43]
v_mov_b32_e64 v226, v216
v_mfma_f32_16x16x32_bf16 v[48:51], v[200:203], v[136:139], v[48:51]
v_mov_b32_e64 v227, v220
v_mfma_f32_16x16x32_bf16 v[52:55], v[200:203], v[140:143], v[52:55]
v_mfma_f32_16x16x32_bf16 v[60:63], v[204:207], v[140:143], v[60:63]
v_mfma_f32_16x16x32_bf16 v[56:59], v[204:207], v[136:139], v[56:59]
s_nop 0
s_branch L_tail
L_exit1:
s_barrier
s_mov_b32 s62, 2
v_mfma_f32_16x16x32_bf16 v[24:27], v[188:191], v[136:139], v[24:27]
ds_read_b64_tr_b16 v[176:177], v240 offset:0
ds_read_b64_tr_b16 v[178:179], v240 offset:512
v_mfma_f32_16x16x32_bf16 v[216:219], v[232:235], v[136:139], v[216:219]
ds_read_b64_tr_b16 v[180:181], v240 offset:32
ds_read_b64_tr_b16 v[182:183], v240 offset:544
v_mfma_f32_16x16x32_bf16 v[32:35], v[192:195], v[136:139], v[32:35]
ds_read_b64_tr_b16 v[184:185], v240 offset:64
ds_read_b64_tr_b16 v[186:187], v240 offset:576
v_mfma_f32_16x16x32_bf16 v[36:39], v[192:195], v[140:143], v[36:39]
ds_read_b64_tr_b16 v[188:189], v240 offset:96
ds_read_b64_tr_b16 v[190:191], v240 offset:608
v_mfma_f32_16x16x32_bf16 v[44:47], v[196:199], v[140:143], v[44:47]
ds_read_b64_tr_b16 v[192:193], v240 offset:128
ds_read_b64_tr_b16 v[194:195], v240 offset:640
v_cvt_pk_bf16_f32 v128, v224, v225
v_cvt_pk_bf16_f32 v129, v226, v227
v_exp_f32 v230, v102
v_exp_f32 v231, v103
v_mfma_f32_16x16x32_bf16 v[40:43], v[196:199], v[136:139], v[40:43]
ds_read_b64_tr_b16 v[196:197], v240 offset:160
ds_read_b64_tr_b16 v[198:199], v240 offset:672
v_cvt_pk_bf16_f32 v132, v228, v229
v_exp_f32 v224, v104
v_exp_f32 v225, v105
v_cvt_pk_bf16_f32 v133, v230, v231
v_mfma_f32_16x16x32_bf16 v[48:51], v[200:203], v[136:139], v[48:51]
v_exp_f32 v226, v106
v_exp_f32 v227, v107
v_cvt_pk_bf16_f32 v130, v224, v225
v_mfma_f32_16x16x32_bf16 v[52:55], v[200:203], v[140:143], v[52:55]
ds_read_b64_tr_b16 v[200:201], v240 offset:192
ds_read_b64_tr_b16 v[202:203], v240 offset:704
v_exp_f32 v228, v108
v_exp_f32 v229, v109
v_cvt_pk_bf16_f32 v131, v226, v227
v_mfma_f32_16x16x32_bf16 v[60:63], v[204:207], v[140:143], v[60:63]
v_exp_f32 v230, v110
v_exp_f32 v231, v111
v_cvt_pk_bf16_f32 v134, v228, v229
v_mfma_f32_16x16x32_bf16 v[56:59], v[204:207], v[136:139], v[56:59]
ds_read_b64_tr_b16 v[204:205], v240 offset:224
ds_read_b64_tr_b16 v[206:207], v240 offset:736
v_or3_b32 v253, v128, v129, v132
v_cvt_pk_bf16_f32 v135, v230, v231
v_or3_b32 v253, v253, v133, v130
v_mfma_f32_16x16x32_bf16 v[220:223], v[232:235], v[140:143], v[220:223]
v_or3_b32 v253, v253, v131, v134
v_bitop3_b32 v253, v253, v135, s63 bitop3:0xa8
v_cmp_ne_u32_e64 vcc, 0, v253
s_cbranch_vccnz L_rare1
L_eb1:
s_waitcnt lgkmcnt(8)
v_mfma_f32_16x16x32_bf16 v[216:219], v[232:235], v[128:131], v[216:219]
s_nop 0
s_and_b32 s6, s40, 1
v_mfma_f32_16x16x32_bf16 v[220:223], v[232:235], v[132:135], v[220:223]
s_nop 0
s_lshl_b32 s4, s2, 1
v_mfma_f32_16x16x32_bf16 v[0:3], v[176:179], v[128:131], v[0:3]
s_nop 0
s_add_u32 s6, s4, s6
v_mfma_f32_16x16x32_bf16 v[4:7], v[176:179], v[132:135], v[4:7]
s_nop 0
s_lshl_b32 s4, s6, 13
v_mfma_f32_16x16x32_bf16 v[12:15], v[180:183], v[132:135], v[12:15]
s_add_u32 s4, s4, 25165824
v_mfma_f32_16x16x32_bf16 v[8:11], v[180:183], v[128:131], v[8:11]
s_nop 0
s_lshl_b32 s7, s6, 8
v_mfma_f32_16x16x32_bf16 v[16:19], v[184:187], v[128:131], v[16:19]
s_add_u32 s7, s7, 29360128
v_mfma_f32_16x16x32_bf16 v[20:23], v[184:187], v[132:135], v[20:23]
s_add_u32 s5, s4, 4096
v_mfma_f32_16x16x32_bf16 v[28:31], v[188:191], v[132:135], v[28:31]
s_nop 0
s_lshr_b32 s3, s40, 1
v_mfma_f32_16x16x32_bf16 v[24:27], v[188:191], v[128:131], v[24:27]
s_nop 0
s_waitcnt lgkmcnt(0)
v_mfma_f32_16x16x32_bf16 v[32:35], v[192:195], v[128:131], v[32:35]
s_nop 0
s_cmp_eq_u32 s3, s41
v_mfma_f32_16x16x32_bf16 v[36:39], v[192:195], v[132:135], v[36:39]
v_mov_b32_e64 v224, v208
v_mfma_f32_16x16x32_bf16 v[44:47], v[196:199], v[132:135], v[44:47]
v_mov_b32_e64 v225, v212
v_mfma_f32_16x16x32_bf16 v[40:43], v[196:199], v[128:131], v[40:43]
v_mov_b32_e64 v226, v216
v_mfma_f32_16x16x32_bf16 v[48:51], v[200:203], v[128:131], v[48:51]
v_mov_b32_e64 v227, v220
v_mfma_f32_16x16x32_bf16 v[52:55], v[200:203], v[132:135], v[52:55]
v_mfma_f32_16x16x32_bf16 v[60:63], v[204:207], v[132:135], v[60:63]
v_mfma_f32_16x16x32_bf16 v[56:59], v[204:207], v[128:131], v[56:59]
L_tail:
s_nop 0
s_cbranch_scc1 L_recv
s_mov_b64 exec, 0xffff
buffer_store_dwordx4 v[224:227], v238, s[36:39], s7 offen sc1
s_mov_b64 exec, -1
s_nop 0
v_cvt_pk_bf16_f32 v144, v0, v1
v_cvt_pk_bf16_f32 v145, v2, v3
v_cvt_pk_bf16_f32 v146, v8, v9
v_cvt_pk_bf16_f32 v147, v10, v11
buffer_store_dwordx4 v[144:147], v238, s[36:39], s4 offen offset:0 sc1
v_cvt_pk_bf16_f32 v148, v4, v5
v_cvt_pk_bf16_f32 v149, v6, v7
v_cvt_pk_bf16_f32 v150, v12, v13
v_cvt_pk_bf16_f32 v151, v14, v15
buffer_store_dwordx4 v[148:151], v238, s[36:39], s4 offen offset:1024 sc1
v_cvt_pk_bf16_f32 v152, v16, v17
v_cvt_pk_bf16_f32 v153, v18, v19
v_cvt_pk_bf16_f32 v154, v24, v25
v_cvt_pk_bf16_f32 v155, v26, v27
buffer_store_dwordx4 v[152:155], v238, s[36:39], s4 offen offset:2048 sc1
v_cvt_pk_bf16_f32 v156, v20, v21
v_cvt_pk_bf16_f32 v157, v22, v23
v_cvt_pk_bf16_f32 v158, v28, v29
v_cvt_pk_bf16_f32 v159, v30, v31
buffer_store_dwordx4 v[156:159], v238, s[36:39], s4 offen offset:3072 sc1
v_cvt_pk_bf16_f32 v160, v32, v33
v_cvt_pk_bf16_f32 v161, v34, v35
v_cvt_pk_bf16_f32 v162, v40, v41
v_cvt_pk_bf16_f32 v163, v42, v43
buffer_store_dwordx4 v[160:163], v238, s[36:39], s5 offen offset:0 sc1
v_cvt_pk_bf16_f32 v164, v36, v37
v_cvt_pk_bf16_f32 v165, v38, v39
v_cvt_pk_bf16_f32 v166, v44, v45
v_cvt_pk_bf16_f32 v167, v46, v47
buffer_store_dwordx4 v[164:167], v238, s[36:39], s5 offen offset:1024 sc1
v_cvt_pk_bf16_f32 v168, v48, v49
v_cvt_pk_bf16_f32 v169, v50, v51
v_cvt_pk_bf16_f32 v170, v56, v57
v_cvt_pk_bf16_f32 v171, v58, v59
buffer_store_dwordx4 v[168:171], v238, s[36:39], s5 offen offset:2048 sc1
v_cvt_pk_bf16_f32 v172, v52, v53
v_cvt_pk_bf16_f32 v173, v54, v55
v_cvt_pk_bf16_f32 v174, v60, v61
v_cvt_pk_bf16_f32 v175, v62, v63
buffer_store_dwordx4 v[172:175], v238, s[36:39], s5 offen offset:3072 sc1
ds_read_b64_tr_b16 a[130:131], v254 offset:33792
ds_read_b64_tr_b16 a[134:135], v254 offset:33800
ds_read_b64_tr_b16 a[138:139], v254 offset:33856
ds_read_b64_tr_b16 a[142:143], v254 offset:33864
ds_read_b64_tr_b16 a[146:147], v254 offset:33920
ds_read_b64_tr_b16 a[150:151], v254 offset:33928
ds_read_b64_tr_b16 a[154:155], v254 offset:33984
ds_read_b64_tr_b16 a[158:159], v254 offset:33992
ds_read_b64_tr_b16 a[160:161], v254 offset:0
ds_read_b64_tr_b16 a[164:165], v254 offset:8
ds_read_b64_tr_b16 a[168:169], v254 offset:64
ds_read_b64_tr_b16 a[172:173], v254 offset:72
ds_read_b64_tr_b16 a[176:177], v254 offset:128
ds_read_b64_tr_b16 a[180:181], v254 offset:136
ds_read_b64_tr_b16 a[184:185], v254 offset:192
ds_read_b64_tr_b16 a[188:189], v254 offset:200
ds_read_b64_tr_b16 a[162:163], v254 offset:50688
ds_read_b64_tr_b16 a[166:167], v254 offset:50696
ds_read_b64_tr_b16 a[170:171], v254 offset:50752
ds_read_b64_tr_b16 a[174:175], v254 offset:50760
ds_read_b64_tr_b16 a[178:179], v254 offset:50816
ds_read_b64_tr_b16 a[182:183], v254 offset:50824
ds_read_b64_tr_b16 a[186:187], v254 offset:50880
ds_read_b64_tr_b16 a[190:191], v254 offset:50888
ds_read_b64_tr_b16 a[192:193], v254 offset:16896
ds_read_b64_tr_b16 a[196:197], v254 offset:16904
ds_read_b64_tr_b16 a[200:201], v254 offset:16960
ds_read_b64_tr_b16 a[204:205], v254 offset:16968
ds_read_b64_tr_b16 a[208:209], v254 offset:17024
ds_read_b64_tr_b16 a[212:213], v254 offset:17032
ds_read_b64_tr_b16 a[216:217], v254 offset:17088
ds_read_b64_tr_b16 a[220:221], v254 offset:17096
s_lshl_b32 s67, s6, 6
s_add_u32 s67, s67, 33587200
v_mov_b32 v247, 1
v_mov_b32 v248, 0
v_add_u32 v251, s44, v238
v_subrev_u32 v72, 84480, v254
s_mov_b32 s54, s44
s_cmp_eq_u32 s54, s0
s_cselect_b32 s45, s55, 16896
s_add_u32 s54, s54, s45
v_add_u32_e64 v68, s54, v72
s_cmp_eq_u32 s54, s0
s_cselect_b32 s45, s55, 16896
s_add_u32 s54, s54, s45
v_add_u32_e64 v69, s54, v72
s_cmp_eq_u32 s54, s0
s_cselect_b32 s45, s55, 16896
s_add_u32 s54, s54, s45
v_add_u32 v70, s54, v72
s_mov_b32 s4, 1
s_lshl_b32 s4, s4, 1
s_or_b32 s4, s4, 1
s_xor_b32 s4, s2, s4
s_and_b32 s6, s40, 1
s_lshl_b32 s4, s4, 1
s_add_u32 s64, s4, s6
s_lshl_b32 s7, s64, 6
s_add_u32 s7, s7, 33587200
v_mov_b32 v246, s7
s_lshl_b32 s4, s64, 13
s_add_u32 s4, s4, 25165824
s_lshl_b32 s5, s64, 8
s_add_u32 s5, s5, 29360128
v_and_b32 v101, 0xf0, v238
s_lshl_b32 s6, s6, 13
v_add_u32_e64 v250, s6, v251
s_mul_i32 s6, s6, 9
s_lshr_b32 s6, s6, 3
s_add_u32 s6, s6, 84480
v_add_u32_e64 v100, s6, v238
s_mov_b32 s7, 0xffff0000
s_waitcnt vmcnt(9) lgkmcnt(0)
s_barrier
s_barrier
s_waitcnt vmcnt(0)
s_mov_b64 exec, 1
buffer_store_dword v247, v248, s[36:39], s67 offen sc1
s_mov_b64 exec, -1
ds_read_b128 v[32:35], v100 offset:0
ds_read_b128 v[36:39], v100 offset:1024
ds_read_b128 v[40:43], v100 offset:2048
ds_read_b128 v[44:47], v100 offset:3072
ds_read_b128 v[48:51], v100 offset:4096
ds_read_b128 v[52:55], v100 offset:5120
ds_read_b128 v[56:59], v100 offset:6144
ds_read_b128 v[60:63], v100 offset:7168
ds_read_b128 v[224:227], v100 offset:8192
ds_read_b64_tr_b16 a[194:195], v68 offset:0
ds_read_b64_tr_b16 a[198:199], v68 offset:8
ds_read_b64_tr_b16 a[202:203], v68 offset:64
ds_read_b64_tr_b16 a[206:207], v68 offset:72
ds_read_b64_tr_b16 a[210:211], v68 offset:128
ds_read_b64_tr_b16 a[214:215], v68 offset:136
ds_read_b64_tr_b16 a[218:219], v68 offset:192
ds_read_b64_tr_b16 a[222:223], v68 offset:200
ds_read_b64_tr_b16 a[224:225], v69 offset:0
ds_read_b64_tr_b16 a[228:229], v69 offset:8
ds_read_b64_tr_b16 a[232:233], v69 offset:64
ds_read_b64_tr_b16 a[236:237], v69 offset:72
ds_read_b64_tr_b16 a[240:241], v69 offset:128
ds_read_b64_tr_b16 a[244:245], v69 offset:136
ds_read_b64_tr_b16 a[248:249], v69 offset:192
ds_read_b64_tr_b16 a[252:253], v69 offset:200
ds_read_b64_tr_b16 a[226:227], v70 offset:0
ds_read_b64_tr_b16 a[230:231], v70 offset:8
ds_read_b64_tr_b16 a[234:235], v70 offset:64
ds_read_b64_tr_b16 a[238:239], v70 offset:72
ds_read_b64_tr_b16 a[242:243], v70 offset:128
ds_read_b64_tr_b16 a[246:247], v70 offset:136
ds_read_b64_tr_b16 a[250:251], v70 offset:192
ds_read_b64_tr_b16 a[254:255], v70 offset:200
s_mov_b32 s3, 0x40000
s_mov_b64 exec, 1
L_spinH1s:
v_mov_b32 v247, 0
buffer_atomic_add v247, v246, s[36:39], 0 offen sc0 sc1
s_sub_u32 s3, s3, 1
s_cbranch_scc1 L_spinH1s_x
s_waitcnt vmcnt(0)
v_readfirstlane_b32 s65, v247
s_cmp_lt_u32 s65, 1
s_cbranch_scc1 L_spinH1s
L_spinH1s_x:
s_mov_b64 exec, -1
s_nop 0
buffer_load_dwordx4 v[228:231], v101, s[36:39], s5 offen sc1
s_add_u32 s4, s4, 4096
buffer_load_dwordx4 v[160:163], v238, s[36:39], s4 offen offset:0 sc1
buffer_load_dwordx4 v[164:167], v238, s[36:39], s4 offen offset:1024 sc1
buffer_load_dwordx4 v[168:171], v238, s[36:39], s4 offen offset:2048 sc1
buffer_load_dwordx4 v[172:175], v238, s[36:39], s4 offen offset:3072 sc1
s_waitcnt vmcnt(4) lgkmcnt(0)
v_min_f32 v246, v224, v228
v_min_f32 v247, v225, v229
v_sub_f32 v96, v246, v224
v_sub_f32 v98, v246, v228
v_sub_f32 v97, v247, v225
v_sub_f32 v99, v247, v229
v_exp_f32 v96, v96
v_exp_f32 v97, v97
v_exp_f32 v98, v98
v_exp_f32 v99, v99
v_mul_f32 v246, v96, v226
v_mul_f32_e64 v247, v97, v227
v_fma_f32 v246, v98, v230, v246
v_fma_f32 v247, v99, v231, v247
v_rcp_f32 v246, v246
v_rcp_f32 v247, v247
s_nop 0
v_mul_f32 v96, v96, v246
v_mul_f32 v97, v97, v247
v_mul_f32 v98, v98, v246
v_mul_f32_e64 v99, v99, v247
v_pk_mul_f32 v[32:33], v[96:97], v[32:33] op_sel:[0,0] op_sel_hi:[0,1]
v_pk_mul_f32 v[34:35], v[96:97], v[34:35] op_sel:[0,0] op_sel_hi:[0,1]
v_pk_mul_f32 v[40:41], v[96:97], v[40:41] op_sel:[0,0] op_sel_hi:[0,1]
v_pk_mul_f32 v[42:43], v[96:97], v[42:43] op_sel:[0,0] op_sel_hi:[0,1]
s_waitcnt vmcnt(3)
v_lshlrev_b32 v248, 16, v160
v_and_b32_e64 v249, s7, v160
v_pk_fma_f32 v[248:249], v[98:99], v[248:249], v[32:33] op_sel:[0,0,0] op_sel_hi:[0,1,1]
v_cvt_pk_bf16_f32 v160, v248, v249
v_lshlrev_b32 v248, 16, v161
v_and_b32 v249, s7, v161
v_pk_fma_f32 v[248:249], v[98:99], v[248:249], v[34:35] op_sel:[0,0,0] op_sel_hi:[0,1,1]
v_cvt_pk_bf16_f32 v161, v248, v249
v_lshlrev_b32 v248, 16, v162
v_and_b32 v249, s7, v162
v_pk_fma_f32 v[248:249], v[98:99], v[248:249], v[40:41] op_sel:[0,0,0] op_sel_hi:[0,1,1]
v_cvt_pk_bf16_f32 v162, v248, v249
v_lshlrev_b32 v248, 16, v163
v_and_b32 v249, s7, v163
v_pk_fma_f32 v[248:249], v[98:99], v[248:249], v[42:43] op_sel:[0,0,0] op_sel_hi:[0,1,1]
v_cvt_pk_bf16_f32 v163, v248, v249
ds_write_b128 v250, v[160:163] offset:4096
v_pk_mul_f32 v[36:37], v[96:97], v[36:37] op_sel:[1,0] op_sel_hi:[1,1]
v_pk_mul_f32 v[38:39], v[96:97], v[38:39] op_sel:[1,0] op_sel_hi:[1,1]
v_pk_mul_f32 v[44:45], v[96:97], v[44:45] op_sel:[1,0] op_sel_hi:[1,1]
v_pk_mul_f32 v[46:47], v[96:97], v[46:47] op_sel:[1,0] op_sel_hi:[1,1]
s_waitcnt vmcnt(2)
v_lshlrev_b32 v248, 16, v164
v_and_b32_e64 v249, s7, v164
v_pk_fma_f32 v[248:249], v[98:99], v[248:249], v[36:37] op_sel:[1,0,0] op_sel_hi:[1,1,1]
v_cvt_pk_bf16_f32 v164, v248, v249
v_lshlrev_b32 v248, 16, v165
v_and_b32 v249, s7, v165
v_pk_fma_f32 v[248:249], v[98:99], v[248:249], v[38:39] op_sel:[1,0,0] op_sel_hi:[1,1,1]
v_cvt_pk_bf16_f32 v165, v248, v249
v_lshlrev_b32 v248, 16, v166
v_and_b32 v249, s7, v166
v_pk_fma_f32 v[248:249], v[98:99], v[248:249], v[44:45] op_sel:[1,0,0] op_sel_hi:[1,1,1]
v_cvt_pk_bf16_f32 v166, v248, v249
v_lshlrev_b32 v248, 16, v167
v_and_b32 v249, s7, v167
v_pk_fma_f32 v[248:249], v[98:99], v[248:249], v[46:47] op_sel:[1,0,0] op_sel_hi:[1,1,1]
v_cvt_pk_bf16_f32 v167, v248, v249
ds_write_b128 v250, v[164:167] offset:5120
v_pk_mul_f32 v[48:49], v[96:97], v[48:49] op_sel:[0,0] op_sel_hi:[0,1]
v_pk_mul_f32 v[50:51], v[96:97], v[50:51] op_sel:[0,0] op_sel_hi:[0,1]
v_pk_mul_f32 v[56:57], v[96:97], v[56:57] op_sel:[0,0] op_sel_hi:[0,1]
v_pk_mul_f32 v[58:59], v[96:97], v[58:59] op_sel:[0,0] op_sel_hi:[0,1]
s_waitcnt vmcnt(1)
v_lshlrev_b32 v248, 16, v168
v_and_b32_e64 v249, s7, v168
v_pk_fma_f32 v[248:249], v[98:99], v[248:249], v[48:49] op_sel:[0,0,0] op_sel_hi:[0,1,1]
v_cvt_pk_bf16_f32 v168, v248, v249
v_lshlrev_b32 v248, 16, v169
v_and_b32 v249, s7, v169
v_pk_fma_f32 v[248:249], v[98:99], v[248:249], v[50:51] op_sel:[0,0,0] op_sel_hi:[0,1,1]
v_cvt_pk_bf16_f32 v169, v248, v249
v_lshlrev_b32 v248, 16, v170
v_and_b32 v249, s7, v170
v_pk_fma_f32 v[248:249], v[98:99], v[248:249], v[56:57] op_sel:[0,0,0] op_sel_hi:[0,1,1]
v_cvt_pk_bf16_f32 v170, v248, v249
v_lshlrev_b32 v248, 16, v171
v_and_b32 v249, s7, v171
v_pk_fma_f32 v[248:249], v[98:99], v[248:249], v[58:59] op_sel:[0,0,0] op_sel_hi:[0,1,1]
v_cvt_pk_bf16_f32 v171, v248, v249
ds_write_b128 v250, v[168:171] offset:6144
v_pk_mul_f32 v[52:53], v[96:97], v[52:53] op_sel:[1,0] op_sel_hi:[1,1]
v_pk_mul_f32 v[54:55], v[96:97], v[54:55] op_sel:[1,0] op_sel_hi:[1,1]
v_pk_mul_f32 v[60:61], v[96:97], v[60:61] op_sel:[1,0] op_sel_hi:[1,1]
v_pk_mul_f32 v[62:63], v[96:97], v[62:63] op_sel:[1,0] op_sel_hi:[1,1]
s_waitcnt vmcnt(0)
v_lshlrev_b32 v248, 16, v172
v_and_b32_e64 v249, s7, v172
v_pk_fma_f32 v[248:249], v[98:99], v[248:249], v[52:53] op_sel:[1,0,0] op_sel_hi:[1,1,1]
v_cvt_pk_bf16_f32 v172, v248, v249
v_lshlrev_b32 v248, 16, v173
v_and_b32 v249, s7, v173
v_pk_fma_f32 v[248:249], v[98:99], v[248:249], v[54:55] op_sel:[1,0,0] op_sel_hi:[1,1,1]
v_cvt_pk_bf16_f32 v173, v248, v249
v_lshlrev_b32 v248, 16, v174
v_and_b32 v249, s7, v174
v_pk_fma_f32 v[248:249], v[98:99], v[248:249], v[60:61] op_sel:[1,0,0] op_sel_hi:[1,1,1]
v_cvt_pk_bf16_f32 v174, v248, v249
v_lshlrev_b32 v248, 16, v175
v_and_b32 v249, s7, v175
v_pk_fma_f32 v[248:249], v[98:99], v[248:249], v[62:63] op_sel:[1,0,0] op_sel_hi:[1,1,1]
v_cvt_pk_bf16_f32 v175, v248, v249
ds_write_b128 v250, v[172:175] offset:7168
s_waitcnt lgkmcnt(0)
s_branch L_gemm
L_recv:
ds_read_b64_tr_b16 a[130:131], v254 offset:33792
ds_read_b64_tr_b16 a[134:135], v254 offset:33800
ds_read_b64_tr_b16 a[138:139], v254 offset:33856
ds_read_b64_tr_b16 a[142:143], v254 offset:33864
ds_read_b64_tr_b16 a[146:147], v254 offset:33920
ds_read_b64_tr_b16 a[150:151], v254 offset:33928
ds_read_b64_tr_b16 a[154:155], v254 offset:33984
ds_read_b64_tr_b16 a[158:159], v254 offset:33992
ds_read_b64_tr_b16 a[160:161], v254 offset:0
ds_read_b64_tr_b16 a[164:165], v254 offset:8
ds_read_b64_tr_b16 a[168:169], v254 offset:64
ds_read_b64_tr_b16 a[172:173], v254 offset:72
ds_read_b64_tr_b16 a[176:177], v254 offset:128
ds_read_b64_tr_b16 a[180:181], v254 offset:136
ds_read_b64_tr_b16 a[184:185], v254 offset:192
ds_read_b64_tr_b16 a[188:189], v254 offset:200
ds_read_b64_tr_b16 a[162:163], v254 offset:50688
ds_read_b64_tr_b16 a[166:167], v254 offset:50696
ds_read_b64_tr_b16 a[170:171], v254 offset:50752
ds_read_b64_tr_b16 a[174:175], v254 offset:50760
ds_read_b64_tr_b16 a[178:179], v254 offset:50816
ds_read_b64_tr_b16 a[182:183], v254 offset:50824
ds_read_b64_tr_b16 a[186:187], v254 offset:50880
ds_read_b64_tr_b16 a[190:191], v254 offset:50888
ds_read_b64_tr_b16 a[192:193], v254 offset:16896
ds_read_b64_tr_b16 a[196:197], v254 offset:16904
ds_read_b64_tr_b16 a[200:201], v254 offset:16960
ds_read_b64_tr_b16 a[204:205], v254 offset:16968
ds_read_b64_tr_b16 a[208:209], v254 offset:17024
ds_read_b64_tr_b16 a[212:213], v254 offset:17032
ds_read_b64_tr_b16 a[216:217], v254 offset:17088
ds_read_b64_tr_b16 a[220:221], v254 offset:17096
v_add_u32_e64 v251, s44, v238
v_subrev_u32 v72, 84480, v254
s_mov_b32 s54, s44
s_cmp_eq_u32 s54, s0
s_cselect_b32 s45, s55, 16896
s_add_u32 s54, s54, s45
v_add_u32_e64 v68, s54, v72
s_cmp_eq_u32 s54, s0
s_cselect_b32 s45, s55, 16896
s_add_u32 s54, s54, s45
v_add_u32_e64 v69, s54, v72
s_cmp_eq_u32 s54, s0
s_cselect_b32 s45, s55, 16896
s_add_u32 s54, s54, s45
v_add_u32 v70, s54, v72
s_mov_b32 s4, 1
s_lshl_b32 s4, s4, 1
s_or_b32 s4, s4, 1
s_xor_b32 s4, s2, s4
s_and_b32 s6, s40, 1
s_lshl_b32 s4, s4, 1
s_add_u32 s64, s4, s6
s_lshl_b32 s7, s64, 6
s_add_u32 s7, s7, 33587200
v_mov_b32 v246, s7
s_lshl_b32 s4, s64, 13
s_add_u32 s4, s4, 25165824
s_lshl_b32 s5, s64, 8
s_add_u32 s5, s5, 29360128
v_and_b32 v101, 0xf0, v238
s_lshl_b32 s6, s6, 13
v_add_u32_e64 v250, s6, v251
s_mul_i32 s6, s6, 9
s_lshr_b32 s6, s6, 3
s_add_u32 s6, s6, 84480
v_add_u32_e64 v100, s6, v238
s_mov_b32 s7, 0xffff0000
s_waitcnt vmcnt(0) lgkmcnt(0)
s_barrier
ds_write_b128 v100, v[32:35] offset:0
ds_write_b128 v100, v[36:39] offset:1024
ds_write_b128 v100, v[40:43] offset:2048
ds_write_b128 v100, v[44:47] offset:3072
ds_write_b128 v100, v[48:51] offset:4096
ds_write_b128 v100, v[52:55] offset:5120
ds_write_b128 v100, v[56:59] offset:6144
ds_write_b128 v100, v[60:63] offset:7168
ds_write_b128 v100, v[224:227] offset:8192
s_waitcnt lgkmcnt(0)
s_barrier
ds_read_b64_tr_b16 a[194:195], v68 offset:0
ds_read_b64_tr_b16 a[198:199], v68 offset:8
ds_read_b64_tr_b16 a[202:203], v68 offset:64
ds_read_b64_tr_b16 a[206:207], v68 offset:72
ds_read_b64_tr_b16 a[210:211], v68 offset:128
ds_read_b64_tr_b16 a[214:215], v68 offset:136
ds_read_b64_tr_b16 a[218:219], v68 offset:192
ds_read_b64_tr_b16 a[222:223], v68 offset:200
ds_read_b64_tr_b16 a[224:225], v69 offset:0
ds_read_b64_tr_b16 a[228:229], v69 offset:8
ds_read_b64_tr_b16 a[232:233], v69 offset:64
ds_read_b64_tr_b16 a[236:237], v69 offset:72
ds_read_b64_tr_b16 a[240:241], v69 offset:128
ds_read_b64_tr_b16 a[244:245], v69 offset:136
ds_read_b64_tr_b16 a[248:249], v69 offset:192
ds_read_b64_tr_b16 a[252:253], v69 offset:200
ds_read_b64_tr_b16 a[226:227], v70 offset:0
ds_read_b64_tr_b16 a[230:231], v70 offset:8
ds_read_b64_tr_b16 a[234:235], v70 offset:64
ds_read_b64_tr_b16 a[238:239], v70 offset:72
ds_read_b64_tr_b16 a[242:243], v70 offset:128
ds_read_b64_tr_b16 a[246:247], v70 offset:136
ds_read_b64_tr_b16 a[250:251], v70 offset:192
ds_read_b64_tr_b16 a[254:255], v70 offset:200
s_mov_b32 s3, 0x40000
s_mov_b64 exec, 1
L_spinH1:
v_mov_b32 v247, 0
buffer_atomic_add v247, v246, s[36:39], 0 offen sc0 sc1
s_sub_u32 s3, s3, 1
s_cbranch_scc1 L_spinH1_x
s_waitcnt vmcnt(0)
v_readfirstlane_b32 s65, v247
s_cmp_lt_u32 s65, 1
s_cbranch_scc1 L_spinH1
L_spinH1_x:
s_mov_b64 exec, -1
s_nop 0
buffer_load_dwordx4 v[228:231], v101, s[36:39], s5 offen sc1
buffer_load_dwordx4 v[144:147], v238, s[36:39], s4 offen offset:0 sc1
buffer_load_dwordx4 v[148:151], v238, s[36:39], s4 offen offset:1024 sc1
buffer_load_dwordx4 v[152:155], v238, s[36:39], s4 offen offset:2048 sc1
buffer_load_dwordx4 v[156:159], v238, s[36:39], s4 offen offset:3072 sc1
s_waitcnt vmcnt(4) lgkmcnt(0)
v_min_f32 v246, v224, v228
v_min_f32 v247, v225, v229
v_sub_f32 v96, v246, v224
v_sub_f32 v98, v246, v228
v_sub_f32 v97, v247, v225
v_sub_f32 v99, v247, v229
v_exp_f32 v96, v96
v_exp_f32 v97, v97
v_exp_f32 v98, v98
v_exp_f32 v99, v99
v_mul_f32 v246, v96, v226
v_mul_f32_e64 v247, v97, v227
v_fma_f32 v246, v98, v230, v246
v_fma_f32 v247, v99, v231, v247
v_rcp_f32 v246, v246
v_rcp_f32 v247, v247
s_nop 0
v_mul_f32 v96, v96, v246
v_mul_f32 v97, v97, v247
v_mul_f32 v98, v98, v246
v_mul_f32_e64 v99, v99, v247
v_pk_mul_f32 v[0:1], v[96:97], v[0:1] op_sel:[0,0] op_sel_hi:[0,1]
v_pk_mul_f32 v[2:3], v[96:97], v[2:3] op_sel:[0,0] op_sel_hi:[0,1]
v_pk_mul_f32 v[8:9], v[96:97], v[8:9] op_sel:[0,0] op_sel_hi:[0,1]
v_pk_mul_f32 v[10:11], v[96:97], v[10:11] op_sel:[0,0] op_sel_hi:[0,1]
s_waitcnt vmcnt(3)
v_lshlrev_b32 v248, 16, v144
v_and_b32_e64 v249, s7, v144
v_pk_fma_f32 v[248:249], v[98:99], v[248:249], v[0:1] op_sel:[0,0,0] op_sel_hi:[0,1,1]
v_cvt_pk_bf16_f32 v144, v248, v249
v_lshlrev_b32 v248, 16, v145
v_and_b32 v249, s7, v145
v_pk_fma_f32 v[248:249], v[98:99], v[248:249], v[2:3] op_sel:[0,0,0] op_sel_hi:[0,1,1]
v_cvt_pk_bf16_f32 v145, v248, v249
v_lshlrev_b32 v248, 16, v146
v_and_b32 v249, s7, v146
v_pk_fma_f32 v[248:249], v[98:99], v[248:249], v[8:9] op_sel:[0,0,0] op_sel_hi:[0,1,1]
v_cvt_pk_bf16_f32 v146, v248, v249
v_lshlrev_b32 v248, 16, v147
v_and_b32 v249, s7, v147
v_pk_fma_f32 v[248:249], v[98:99], v[248:249], v[10:11] op_sel:[0,0,0] op_sel_hi:[0,1,1]
v_cvt_pk_bf16_f32 v147, v248, v249
ds_write_b128 v250, v[144:147] offset:0
v_pk_mul_f32 v[4:5], v[96:97], v[4:5] op_sel:[1,0] op_sel_hi:[1,1]
v_pk_mul_f32 v[6:7], v[96:97], v[6:7] op_sel:[1,0] op_sel_hi:[1,1]
v_pk_mul_f32 v[12:13], v[96:97], v[12:13] op_sel:[1,0] op_sel_hi:[1,1]
v_pk_mul_f32 v[14:15], v[96:97], v[14:15] op_sel:[1,0] op_sel_hi:[1,1]
s_waitcnt vmcnt(2)
v_lshlrev_b32 v248, 16, v148
v_and_b32_e64 v249, s7, v148
v_pk_fma_f32 v[248:249], v[98:99], v[248:249], v[4:5] op_sel:[1,0,0] op_sel_hi:[1,1,1]
v_cvt_pk_bf16_f32 v148, v248, v249
v_lshlrev_b32 v248, 16, v149
v_and_b32 v249, s7, v149
v_pk_fma_f32 v[248:249], v[98:99], v[248:249], v[6:7] op_sel:[1,0,0] op_sel_hi:[1,1,1]
v_cvt_pk_bf16_f32 v149, v248, v249
v_lshlrev_b32 v248, 16, v150
v_and_b32 v249, s7, v150
v_pk_fma_f32 v[248:249], v[98:99], v[248:249], v[12:13] op_sel:[1,0,0] op_sel_hi:[1,1,1]
v_cvt_pk_bf16_f32 v150, v248, v249
v_lshlrev_b32 v248, 16, v151
v_and_b32 v249, s7, v151
v_pk_fma_f32 v[248:249], v[98:99], v[248:249], v[14:15] op_sel:[1,0,0] op_sel_hi:[1,1,1]
v_cvt_pk_bf16_f32 v151, v248, v249
ds_write_b128 v250, v[148:151] offset:1024
v_pk_mul_f32 v[16:17], v[96:97], v[16:17] op_sel:[0,0] op_sel_hi:[0,1]
v_pk_mul_f32 v[18:19], v[96:97], v[18:19] op_sel:[0,0] op_sel_hi:[0,1]
v_pk_mul_f32 v[24:25], v[96:97], v[24:25] op_sel:[0,0] op_sel_hi:[0,1]
v_pk_mul_f32 v[26:27], v[96:97], v[26:27] op_sel:[0,0] op_sel_hi:[0,1]
s_waitcnt vmcnt(1)
v_lshlrev_b32 v248, 16, v152
v_and_b32_e64 v249, s7, v152
v_pk_fma_f32 v[248:249], v[98:99], v[248:249], v[16:17] op_sel:[0,0,0] op_sel_hi:[0,1,1]
v_cvt_pk_bf16_f32 v152, v248, v249
v_lshlrev_b32 v248, 16, v153
v_and_b32 v249, s7, v153
v_pk_fma_f32 v[248:249], v[98:99], v[248:249], v[18:19] op_sel:[0,0,0] op_sel_hi:[0,1,1]
v_cvt_pk_bf16_f32 v153, v248, v249
v_lshlrev_b32 v248, 16, v154
v_and_b32 v249, s7, v154
v_pk_fma_f32 v[248:249], v[98:99], v[248:249], v[24:25] op_sel:[0,0,0] op_sel_hi:[0,1,1]
v_cvt_pk_bf16_f32 v154, v248, v249
v_lshlrev_b32 v248, 16, v155
v_and_b32 v249, s7, v155
v_pk_fma_f32 v[248:249], v[98:99], v[248:249], v[26:27] op_sel:[0,0,0] op_sel_hi:[0,1,1]
v_cvt_pk_bf16_f32 v155, v248, v249
ds_write_b128 v250, v[152:155] offset:2048
v_pk_mul_f32 v[20:21], v[96:97], v[20:21] op_sel:[1,0] op_sel_hi:[1,1]
v_pk_mul_f32 v[22:23], v[96:97], v[22:23] op_sel:[1,0] op_sel_hi:[1,1]
v_pk_mul_f32 v[28:29], v[96:97], v[28:29] op_sel:[1,0] op_sel_hi:[1,1]
v_pk_mul_f32 v[30:31], v[96:97], v[30:31] op_sel:[1,0] op_sel_hi:[1,1]
s_waitcnt vmcnt(0)
v_lshlrev_b32 v248, 16, v156
v_and_b32_e64 v249, s7, v156
v_pk_fma_f32 v[248:249], v[98:99], v[248:249], v[20:21] op_sel:[1,0,0] op_sel_hi:[1,1,1]
v_cvt_pk_bf16_f32 v156, v248, v249
v_lshlrev_b32 v248, 16, v157
v_and_b32 v249, s7, v157
v_pk_fma_f32 v[248:249], v[98:99], v[248:249], v[22:23] op_sel:[1,0,0] op_sel_hi:[1,1,1]
v_cvt_pk_bf16_f32 v157, v248, v249
v_lshlrev_b32 v248, 16, v158
v_and_b32 v249, s7, v158
v_pk_fma_f32 v[248:249], v[98:99], v[248:249], v[28:29] op_sel:[1,0,0] op_sel_hi:[1,1,1]
v_cvt_pk_bf16_f32 v158, v248, v249
v_lshlrev_b32 v248, 16, v159
v_and_b32 v249, s7, v159
v_pk_fma_f32 v[248:249], v[98:99], v[248:249], v[30:31] op_sel:[1,0,0] op_sel_hi:[1,1,1]
v_cvt_pk_bf16_f32 v159, v248, v249
ds_write_b128 v250, v[156:159] offset:3072
s_waitcnt lgkmcnt(0)
L_gemm:
s_barrier
ds_read_b128 v[144:147], v251 offset:0
ds_read_b128 v[148:151], v251 offset:1024
ds_read_b128 v[152:155], v251 offset:2048
ds_read_b128 v[156:159], v251 offset:3072
ds_read_b128 v[160:163], v251 offset:4096
ds_read_b128 v[164:167], v251 offset:5120
ds_read_b128 v[168:171], v251 offset:6144
ds_read_b128 v[172:175], v251 offset:7168
ds_read_b128 v[176:179], v251 offset:8192
ds_read_b128 v[180:183], v251 offset:9216
ds_read_b128 v[184:187], v251 offset:10240
ds_read_b128 v[188:191], v251 offset:11264
s_lshl_b32 s4, s42, 19
s_lshl_b32 s5, s40, 17
s_add_u32 s4, s4, s5
s_and_b32 s6, s2, 15
s_lshl_b32 s5, s6, 11
s_add_u32 s4, s4, s5
s_add_u32 s4, s4, 16777216
s_waitcnt lgkmcnt(10)
s_nop 0
v_mfma_f32_16x16x32_bf16 v[0:3], a[0:3], v[144:147], 0
ds_read_b128 v[192:195], v251 offset:12288
v_mfma_f32_16x16x32_bf16 v[4:7], a[0:3], v[148:151], 0
ds_read_b128 v[196:199], v251 offset:13312
v_mfma_f32_16x16x32_bf16 v[12:15], a[4:7], v[148:151], 0
v_mfma_f32_16x16x32_bf16 v[8:11], a[4:7], v[144:147], 0
s_nop 0
s_waitcnt lgkmcnt(10)
v_mfma_f32_16x16x32_bf16 v[0:3], a[32:35], v[152:155], v[0:3]
ds_read_b128 v[200:203], v251 offset:14336
v_mfma_f32_16x16x32_bf16 v[4:7], a[32:35], v[156:159], v[4:7]
ds_read_b128 v[204:207], v251 offset:15360
v_mfma_f32_16x16x32_bf16 v[12:15], a[36:39], v[156:159], v[12:15]
v_mfma_f32_16x16x32_bf16 v[8:11], a[36:39], v[152:155], v[8:11]
s_nop 0
s_waitcnt lgkmcnt(10)
v_mfma_f32_16x16x32_bf16 v[0:3], a[64:67], v[160:163], v[0:3]
v_mfma_f32_16x16x32_bf16 v[4:7], a[64:67], v[164:167], v[4:7]
v_mfma_f32_16x16x32_bf16 v[12:15], a[68:71], v[164:167], v[12:15]
v_mfma_f32_16x16x32_bf16 v[8:11], a[68:71], v[160:163], v[8:11]
s_nop 0
s_waitcnt lgkmcnt(8)
v_mfma_f32_16x16x32_bf16 v[0:3], a[96:99], v[168:171], v[0:3]
v_mfma_f32_16x16x32_bf16 v[4:7], a[96:99], v[172:175], v[4:7]
v_mfma_f32_16x16x32_bf16 v[12:15], a[100:103], v[172:175], v[12:15]
v_mfma_f32_16x16x32_bf16 v[8:11], a[100:103], v[168:171], v[8:11]
s_nop 0
s_waitcnt lgkmcnt(6)
v_mfma_f32_16x16x32_bf16 v[0:3], a[128:131], v[176:179], v[0:3]
v_mfma_f32_16x16x32_bf16 v[4:7], a[128:131], v[180:183], v[4:7]
v_mfma_f32_16x16x32_bf16 v[12:15], a[132:135], v[180:183], v[12:15]
v_mfma_f32_16x16x32_bf16 v[8:11], a[132:135], v[176:179], v[8:11]
s_nop 0
s_waitcnt lgkmcnt(4)
v_mfma_f32_16x16x32_bf16 v[0:3], a[160:163], v[184:187], v[0:3]
v_mfma_f32_16x16x32_bf16 v[4:7], a[160:163], v[188:191], v[4:7]
v_mfma_f32_16x16x32_bf16 v[12:15], a[164:167], v[188:191], v[12:15]
v_mfma_f32_16x16x32_bf16 v[8:11], a[164:167], v[184:187], v[8:11]
s_nop 0
s_waitcnt lgkmcnt(2)
v_mfma_f32_16x16x32_bf16 v[0:3], a[192:195], v[192:195], v[0:3]
v_mfma_f32_16x16x32_bf16 v[4:7], a[192:195], v[196:199], v[4:7]
v_mfma_f32_16x16x32_bf16 v[12:15], a[196:199], v[196:199], v[12:15]
v_mfma_f32_16x16x32_bf16 v[8:11], a[196:199], v[192:195], v[8:11]
s_nop 0
s_waitcnt lgkmcnt(0)
v_mfma_f32_16x16x32_bf16 v[0:3], a[224:227], v[200:203], v[0:3]
v_mfma_f32_16x16x32_bf16 v[4:7], a[224:227], v[204:207], v[4:7]
v_mfma_f32_16x16x32_bf16 v[12:15], a[228:231], v[204:207], v[12:15]
v_mfma_f32_16x16x32_bf16 v[8:11], a[228:231], v[200:203], v[8:11]
v_mfma_f32_16x16x32_bf16 v[16:19], a[8:11], v[144:147], 0
v_mfma_f32_16x16x32_bf16 v[20:23], a[8:11], v[148:151], 0
v_mfma_f32_16x16x32_bf16 v[28:31], a[12:15], v[148:151], 0
v_mfma_f32_16x16x32_bf16 v[24:27], a[12:15], v[144:147], 0
v_mfma_f32_16x16x32_bf16 v[16:19], a[40:43], v[152:155], v[16:19]
v_mfma_f32_16x16x32_bf16 v[20:23], a[40:43], v[156:159], v[20:23]
v_mfma_f32_16x16x32_bf16 v[28:31], a[44:47], v[156:159], v[28:31]
v_mfma_f32_16x16x32_bf16 v[24:27], a[44:47], v[152:155], v[24:27]
v_mfma_f32_16x16x32_bf16 v[16:19], a[72:75], v[160:163], v[16:19]
v_cvt_pk_bf16_f32 v96, v0, v1
v_mfma_f32_16x16x32_bf16 v[20:23], a[72:75], v[164:167], v[20:23]
v_cvt_pk_bf16_f32 v97, v2, v3
v_mfma_f32_16x16x32_bf16 v[28:31], a[76:79], v[164:167], v[28:31]
v_cvt_pk_bf16_f32 v98, v8, v9
v_mfma_f32_16x16x32_bf16 v[24:27], a[76:79], v[160:163], v[24:27]
v_cvt_pk_bf16_f32 v99, v10, v11
v_mfma_f32_16x16x32_bf16 v[16:19], a[104:107], v[168:171], v[16:19]
buffer_store_dwordx4 v[96:99], v238, s[36:39], s4 offen offset:0 sc1
v_mfma_f32_16x16x32_bf16 v[20:23], a[104:107], v[172:175], v[20:23]
v_cvt_pk_bf16_f32 v100, v4, v5
v_mfma_f32_16x16x32_bf16 v[28:31], a[108:111], v[172:175], v[28:31]
v_cvt_pk_bf16_f32 v101, v6, v7
v_mfma_f32_16x16x32_bf16 v[24:27], a[108:111], v[168:171], v[24:27]
v_cvt_pk_bf16_f32 v102, v12, v13
v_mfma_f32_16x16x32_bf16 v[16:19], a[136:139], v[176:179], v[16:19]
v_cvt_pk_bf16_f32 v103, v14, v15
v_mfma_f32_16x16x32_bf16 v[20:23], a[136:139], v[180:183], v[20:23]
buffer_store_dwordx4 v[100:103], v238, s[36:39], s4 offen offset:1024 sc1
v_mfma_f32_16x16x32_bf16 v[28:31], a[140:143], v[180:183], v[28:31]
s_add_u32 s4, s4, 32768
v_mfma_f32_16x16x32_bf16 v[24:27], a[140:143], v[176:179], v[24:27]
v_mfma_f32_16x16x32_bf16 v[16:19], a[168:171], v[184:187], v[16:19]
v_mfma_f32_16x16x32_bf16 v[20:23], a[168:171], v[188:191], v[20:23]
v_mfma_f32_16x16x32_bf16 v[28:31], a[172:175], v[188:191], v[28:31]
v_mfma_f32_16x16x32_bf16 v[24:27], a[172:175], v[184:187], v[24:27]
v_mfma_f32_16x16x32_bf16 v[16:19], a[200:203], v[192:195], v[16:19]
v_mfma_f32_16x16x32_bf16 v[20:23], a[200:203], v[196:199], v[20:23]
v_mfma_f32_16x16x32_bf16 v[28:31], a[204:207], v[196:199], v[28:31]
v_mfma_f32_16x16x32_bf16 v[24:27], a[204:207], v[192:195], v[24:27]
v_mfma_f32_16x16x32_bf16 v[16:19], a[232:235], v[200:203], v[16:19]
v_mfma_f32_16x16x32_bf16 v[20:23], a[232:235], v[204:207], v[20:23]
v_mfma_f32_16x16x32_bf16 v[28:31], a[236:239], v[204:207], v[28:31]
v_mfma_f32_16x16x32_bf16 v[24:27], a[236:239], v[200:203], v[24:27]
v_mfma_f32_16x16x32_bf16 v[32:35], a[16:19], v[144:147], 0
v_mfma_f32_16x16x32_bf16 v[36:39], a[16:19], v[148:151], 0
v_mfma_f32_16x16x32_bf16 v[44:47], a[20:23], v[148:151], 0
v_mfma_f32_16x16x32_bf16 v[40:43], a[20:23], v[144:147], 0
v_mfma_f32_16x16x32_bf16 v[32:35], a[48:51], v[152:155], v[32:35]
v_mfma_f32_16x16x32_bf16 v[36:39], a[48:51], v[156:159], v[36:39]
v_mfma_f32_16x16x32_bf16 v[44:47], a[52:55], v[156:159], v[44:47]
v_mfma_f32_16x16x32_bf16 v[40:43], a[52:55], v[152:155], v[40:43]
v_mfma_f32_16x16x32_bf16 v[32:35], a[80:83], v[160:163], v[32:35]
v_cvt_pk_bf16_f32 v104, v16, v17
v_mfma_f32_16x16x32_bf16 v[36:39], a[80:83], v[164:167], v[36:39]
v_cvt_pk_bf16_f32 v105, v18, v19
v_mfma_f32_16x16x32_bf16 v[44:47], a[84:87], v[164:167], v[44:47]
v_cvt_pk_bf16_f32 v106, v24, v25
v_mfma_f32_16x16x32_bf16 v[40:43], a[84:87], v[160:163], v[40:43]
v_cvt_pk_bf16_f32 v107, v26, v27
v_mfma_f32_16x16x32_bf16 v[32:35], a[112:115], v[168:171], v[32:35]
buffer_store_dwordx4 v[104:107], v238, s[36:39], s4 offen offset:0 sc1
v_mfma_f32_16x16x32_bf16 v[36:39], a[112:115], v[172:175], v[36:39]
v_cvt_pk_bf16_f32 v108, v20, v21
v_mfma_f32_16x16x32_bf16 v[44:47], a[116:119], v[172:175], v[44:47]
v_cvt_pk_bf16_f32 v109, v22, v23
v_mfma_f32_16x16x32_bf16 v[40:43], a[116:119], v[168:171], v[40:43]
v_cvt_pk_bf16_f32 v110, v28, v29
v_mfma_f32_16x16x32_bf16 v[32:35], a[144:147], v[176:179], v[32:35]
v_cvt_pk_bf16_f32 v111, v30, v31
v_mfma_f32_16x16x32_bf16 v[36:39], a[144:147], v[180:183], v[36:39]
buffer_store_dwordx4 v[108:111], v238, s[36:39], s4 offen offset:1024 sc1
v_mfma_f32_16x16x32_bf16 v[44:47], a[148:151], v[180:183], v[44:47]
s_add_u32 s4, s4, 32768
v_mfma_f32_16x16x32_bf16 v[40:43], a[148:151], v[176:179], v[40:43]
v_mfma_f32_16x16x32_bf16 v[32:35], a[176:179], v[184:187], v[32:35]
v_mfma_f32_16x16x32_bf16 v[36:39], a[176:179], v[188:191], v[36:39]
v_mfma_f32_16x16x32_bf16 v[44:47], a[180:183], v[188:191], v[44:47]
v_mfma_f32_16x16x32_bf16 v[40:43], a[180:183], v[184:187], v[40:43]
v_mfma_f32_16x16x32_bf16 v[32:35], a[208:211], v[192:195], v[32:35]
v_mfma_f32_16x16x32_bf16 v[36:39], a[208:211], v[196:199], v[36:39]
v_mfma_f32_16x16x32_bf16 v[44:47], a[212:215], v[196:199], v[44:47]
v_mfma_f32_16x16x32_bf16 v[40:43], a[212:215], v[192:195], v[40:43]
v_mfma_f32_16x16x32_bf16 v[32:35], a[240:243], v[200:203], v[32:35]
v_mfma_f32_16x16x32_bf16 v[36:39], a[240:243], v[204:207], v[36:39]
v_mfma_f32_16x16x32_bf16 v[44:47], a[244:247], v[204:207], v[44:47]
v_mfma_f32_16x16x32_bf16 v[40:43], a[244:247], v[200:203], v[40:43]
v_mfma_f32_16x16x32_bf16 v[48:51], a[24:27], v[144:147], 0
v_mfma_f32_16x16x32_bf16 v[52:55], a[24:27], v[148:151], 0
v_mfma_f32_16x16x32_bf16 v[60:63], a[28:31], v[148:151], 0
v_mfma_f32_16x16x32_bf16 v[56:59], a[28:31], v[144:147], 0
v_mfma_f32_16x16x32_bf16 v[48:51], a[56:59], v[152:155], v[48:51]
v_mfma_f32_16x16x32_bf16 v[52:55], a[56:59], v[156:159], v[52:55]
v_mfma_f32_16x16x32_bf16 v[60:63], a[60:63], v[156:159], v[60:63]
v_mfma_f32_16x16x32_bf16 v[56:59], a[60:63], v[152:155], v[56:59]
v_mfma_f32_16x16x32_bf16 v[48:51], a[88:91], v[160:163], v[48:51]
v_cvt_pk_bf16_f32 v112, v32, v33
v_mfma_f32_16x16x32_bf16 v[52:55], a[88:91], v[164:167], v[52:55]
v_cvt_pk_bf16_f32 v113, v34, v35
v_mfma_f32_16x16x32_bf16 v[60:63], a[92:95], v[164:167], v[60:63]
v_cvt_pk_bf16_f32 v114, v40, v41
v_mfma_f32_16x16x32_bf16 v[56:59], a[92:95], v[160:163], v[56:59]
v_cvt_pk_bf16_f32 v115, v42, v43
v_mfma_f32_16x16x32_bf16 v[48:51], a[120:123], v[168:171], v[48:51]
buffer_store_dwordx4 v[112:115], v238, s[36:39], s4 offen offset:0 sc1
v_mfma_f32_16x16x32_bf16 v[52:55], a[120:123], v[172:175], v[52:55]
v_cvt_pk_bf16_f32 v116, v36, v37
v_mfma_f32_16x16x32_bf16 v[60:63], a[124:127], v[172:175], v[60:63]
v_cvt_pk_bf16_f32 v117, v38, v39
v_mfma_f32_16x16x32_bf16 v[56:59], a[124:127], v[168:171], v[56:59]
v_cvt_pk_bf16_f32 v118, v44, v45
v_mfma_f32_16x16x32_bf16 v[48:51], a[152:155], v[176:179], v[48:51]
v_cvt_pk_bf16_f32 v119, v46, v47
v_mfma_f32_16x16x32_bf16 v[52:55], a[152:155], v[180:183], v[52:55]
buffer_store_dwordx4 v[116:119], v238, s[36:39], s4 offen offset:1024 sc1
v_mfma_f32_16x16x32_bf16 v[60:63], a[156:159], v[180:183], v[60:63]
s_add_u32 s4, s4, 32768
v_mfma_f32_16x16x32_bf16 v[56:59], a[156:159], v[176:179], v[56:59]
v_mfma_f32_16x16x32_bf16 v[48:51], a[184:187], v[184:187], v[48:51]
v_mfma_f32_16x16x32_bf16 v[52:55], a[184:187], v[188:191], v[52:55]
v_mfma_f32_16x16x32_bf16 v[60:63], a[188:191], v[188:191], v[60:63]
v_mfma_f32_16x16x32_bf16 v[56:59], a[188:191], v[184:187], v[56:59]
v_mfma_f32_16x16x32_bf16 v[48:51], a[216:219], v[192:195], v[48:51]
v_mfma_f32_16x16x32_bf16 v[52:55], a[216:219], v[196:199], v[52:55]
v_mfma_f32_16x16x32_bf16 v[60:63], a[220:223], v[196:199], v[60:63]
v_mfma_f32_16x16x32_bf16 v[56:59], a[220:223], v[192:195], v[56:59]
v_mfma_f32_16x16x32_bf16 v[48:51], a[248:251], v[200:203], v[48:51]
v_mfma_f32_16x16x32_bf16 v[52:55], a[248:251], v[204:207], v[52:55]
v_mfma_f32_16x16x32_bf16 v[60:63], a[252:255], v[204:207], v[60:63]
v_mfma_f32_16x16x32_bf16 v[56:59], a[252:255], v[200:203], v[56:59]
s_nop 0
s_nop 4
v_cvt_pk_bf16_f32 v120, v48, v49
v_cvt_pk_bf16_f32 v121, v50, v51
s_nop 0
s_nop 0
v_cvt_pk_bf16_f32 v122, v56, v57
v_cvt_pk_bf16_f32 v123, v58, v59
buffer_store_dwordx4 v[120:123], v238, s[36:39], s4 offen offset:0 sc1
v_cvt_pk_bf16_f32 v124, v52, v53
v_cvt_pk_bf16_f32 v125, v54, v55
v_cvt_pk_bf16_f32 v126, v60, v61
v_cvt_pk_bf16_f32 v127, v62, v63
buffer_store_dwordx4 v[124:127], v238, s[36:39], s4 offen offset:1024 sc1
s_lshl_b32 s4, s42, 2
s_add_u32 s5, s4, s40
s_lshl_b32 s5, s5, 7
s_add_u32 s5, s5, 33558528
s_lshr_b32 s7, s6, 2
s_add_u32 s4, s4, s7
s_lshl_b32 s4, s4, 7
s_add_u32 s4, s4, 33558528
v_mov_b32 v246, s4
v_mov_b32 v247, 1
v_mov_b32_e64 v248, 0
s_waitcnt vmcnt(0)
s_mov_b64 exec, 1
buffer_atomic_add v247, v248, s[36:39], s5 offen sc1
s_mov_b64 exec, -1
s_lshl_b32 s5, s42, 19
s_lshl_b32 s7, s6, 15
s_add_u32 s5, s5, s7
s_and_b32 s64, s40, 1
s_lshl_b32 s7, s64, 10
s_add_u32 s5, s5, s7
s_lshr_b32 s66, s40, 1
s_lshl_b32 s7, s66, 7
s_add_u32 s5, s5, s7
s_add_u32 s5, s5, 16777216
v_lshrrev_b32_e64 v224, 8, v238
v_and_b32 v225, 0x70, v238
v_bfe_u32 v226, v238, 7, 1
v_lshl_add_u32 v251, v226, 8, v225
v_lshl_add_u32 v251, v224, 11, v251
v_lshlrev_b32_e64 v250, 6, v225
v_lshl_add_u32 v250, v226, 4, v250
v_and_b32_e64 v226, 1, v224
v_lshl_add_u32 v250, v226, 3, v250
v_lshrrev_b32_e64 v226, 1, v224
v_lshl_add_u32 v250, v226, 5, v250
s_lshl_b32 s7, s42, 15
s_lshl_b32 s6, s6, 6
s_add_u32 s6, s6, s7
s_lshl_b32 s7, s64, 14
s_add_u32 s6, s6, s7
s_lshl_b32 s7, s66, 13
s_add_u32 s6, s6, s7
v_bfe_u32 v224, v238, 4, 1
v_lshlrev_b32 v224, 4, v224
v_mov_b32 v225, 0x3f80
v_lshlrev_b32_e64 v224, v224, v225
v_bfe_u32 v225, v238, 5, 3
v_cmp_eq_u32 vcc, 0, v225
s_nop 1
v_cndmask_b32 v64, 0, v224, vcc
v_cmp_eq_u32 vcc, 1, v225
s_nop 1
v_cndmask_b32 v65, 0, v224, vcc
v_cmp_eq_u32 vcc, 2, v225
s_nop 1
v_cndmask_b32 v66, 0, v224, vcc
v_cmp_eq_u32 vcc, 3, v225
s_nop 1
v_cndmask_b32 v67, 0, v224, vcc
v_cmp_eq_u32 vcc, 4, v225
s_nop 1
v_cndmask_b32 v68, 0, v224, vcc
v_cmp_eq_u32 vcc, 5, v225
s_nop 1
v_cndmask_b32 v69, 0, v224, vcc
v_cmp_eq_u32 vcc, 6, v225
s_nop 1
v_cndmask_b32 v70, 0, v224, vcc
v_cmp_eq_u32 vcc, 7, v225
s_nop 1
v_cndmask_b32 v71, 0, v224, vcc
s_cmp_lg_u32 s40, 0
s_cbranch_scc1 L_h2wait
s_mov_b32 s3, 0x40000
s_mov_b64 exec, 1
L_spinH2:
v_mov_b32 v249, 0
buffer_atomic_add v249, v246, s[36:39], 0 offen sc0 sc1
s_sub_u32 s3, s3, 1
s_cbranch_scc1 L_spinH2_x
s_waitcnt vmcnt(0)
v_readfirstlane_b32 s4, v249
s_cmp_lt_u32 s4, 16
s_cbranch_scc1 L_spinH2
L_spinH2_x:
s_mov_b64 exec, -1
L_h2wait:
s_barrier
buffer_load_dwordx4 v[144:147], v251, s[36:39], s5 offen offset:0 sc1
buffer_load_dwordx4 v[148:151], v251, s[36:39], s5 offen offset:512 sc1
s_add_u32 s5, s5, 8192
buffer_load_dwordx4 v[152:155], v251, s[36:39], s5 offen offset:0 sc1
buffer_load_dwordx4 v[156:159], v251, s[36:39], s5 offen offset:512 sc1
s_add_u32 s5, s5, 8192
buffer_load_dwordx4 v[160:163], v251, s[36:39], s5 offen offset:0 sc1
buffer_load_dwordx4 v[164:167], v251, s[36:39], s5 offen offset:512 sc1
s_add_u32 s5, s5, 8192
buffer_load_dwordx4 v[168:171], v251, s[36:39], s5 offen offset:0 sc1
buffer_load_dwordx4 v[172:175], v251, s[36:39], s5 offen offset:512 sc1
s_waitcnt vmcnt(7)
v_mfma_f32_16x16x32_bf16 v[208:211], v[64:67], v[144:147], 0
s_waitcnt vmcnt(6)
v_mfma_f32_16x16x32_bf16 v[208:211], v[68:71], v[148:151], v[208:211]
s_nop 0
s_waitcnt vmcnt(5)
v_mfma_f32_16x16x32_bf16 v[208:211], v[64:67], v[152:155], v[208:211]
s_nop 0
s_waitcnt vmcnt(4)
v_mfma_f32_16x16x32_bf16 v[208:211], v[68:71], v[156:159], v[208:211]
s_nop 0
s_waitcnt vmcnt(3)
v_mfma_f32_16x16x32_bf16 v[208:211], v[64:67], v[160:163], v[208:211]
s_nop 0
s_waitcnt vmcnt(2)
v_mfma_f32_16x16x32_bf16 v[208:211], v[68:71], v[164:167], v[208:211]
s_nop 0
s_waitcnt vmcnt(1)
v_mfma_f32_16x16x32_bf16 v[208:211], v[64:67], v[168:171], v[208:211]
s_nop 0
s_waitcnt vmcnt(0)
v_mfma_f32_16x16x32_bf16 v[208:211], v[68:71], v[172:175], v[208:211]
s_nop 0
s_nop 7
v_cvt_pk_bf16_f32 v212, v208, v209
v_cvt_pk_bf16_f32 v213, v210, v211
buffer_store_dwordx2 v[212:213], v250, s[28:31], s6 offen sc1
L_done:
L_end:
s_endpgm
L_codeend:
.section .rodata,"a"
.p2align 6
.amdhsa_kernel standalone__gqa_block_cached__sampling_kernel
.amdhsa_next_free_vgpr 512
.amdhsa_next_free_sgpr 102
.amdhsa_accum_offset 256
.amdhsa_group_segment_fixed_size 0
.amdhsa_kernarg_size 64
.amdhsa_user_sgpr_count 2
.amdhsa_user_sgpr_kernarg_segment_ptr 1
.amdhsa_system_sgpr_workgroup_id_x 1
.end_amdhsa_kernel
```
